```python
import torch

def _softmax(x, axis=-1):
    return torch.softmax(x, dim=axis)
def _gelu(x):
    return torch.nn.functional.gelu(x, approximate="tanh")
def _silu(x):
    return torch.nn.functional.silu(x)
def _sigmoid(x):
    return torch.sigmoid(x)
def _layernorm(x, axis=-1, eps=1e-5):
    m = x.mean(dim=axis, keepdim=True)
    v = x.var(dim=axis, keepdim=True, unbiased=False)
    return (x - m) / torch.sqrt(v + eps)
def _scatter_add(tgt, idx, src, axis=0):
    return tgt.clone().index_add_(axis, idx, src)
def _segment_sum(src, seg, n):
    out = torch.zeros((n,) + src.shape[1:], dtype=src.dtype)
    return out.index_add_(0, seg, src)
def _pad(x, pw):
    flat = tuple(v for pair in reversed(pw) for v in pair)
    return torch.nn.functional.pad(x, flat)

kernel_name = 'interleave_layers__sliding_block_cached__dense_activation_silu__decode'

def setup_inputs():

    _w = (lambda a: (lambda t: t.to(torch.bfloat16) if t.is_floating_point() else t)(torch.as_tensor(a)))
    def _A_setup():
        B, Sq, D = 1, 1, 448
        Hq, Hkv, Sk, Dh = 16, 8, 65536, 256
        assert Hq % Hkv == 0, (Hq, Hkv)
        return {
            "x": _w((lambda *s: torch.randn(*s, dtype=torch.bfloat16) * 0.05)(B, Sq, D)),
            "k_cache": _w((lambda *s: torch.randn(*s, dtype=torch.bfloat16) * 0.8)(B, Hkv, Sk, Dh)),
            "v_cache": _w((lambda *s: torch.randn(*s, dtype=torch.bfloat16) * 1.6)(B, Hkv, Sk, Dh)),
            "wq": _w((lambda *s: torch.randn(*s, dtype=torch.bfloat16) * 0.8)(D, Hq * Dh) * (D ** -0.5)),
            "wo": _w((lambda *s: torch.randn(*s, dtype=torch.bfloat16) * 1.6)(Hq * Dh, D) * ((Hq * Dh) ** -0.5)),
        }
    _A_in = _A_setup()

    def _B_setup():
        B, S, D, F = 1, 1, 448, 1792
        return {
            "x": _w((lambda *s: torch.randn(*s, dtype=torch.bfloat16) * 0.05)(B, S, D)),
            "w1": _w((lambda *s: torch.randn(*s, dtype=torch.bfloat16) * 0.4)(D, F) * (D ** -0.5)),
            "w2": _w((lambda *s: torch.randn(*s, dtype=torch.bfloat16) * 0.4)(F, D) * (F ** -0.5)),
        }
    _B_in = _B_setup()

    return {
        "A_x": _A_in["x"],
        "A_k_cache": _A_in["k_cache"],
        "A_v_cache": _A_in["v_cache"],
        "A_wq": _A_in["wq"],
        "A_wo": _A_in["wo"],
        "B_x": _B_in["x"],
        "B_w1": _B_in["w1"],
        "B_w2": _B_in["w2"],
    }

def reference(A_x, A_k_cache, A_v_cache, A_wq, A_wo, B_x, B_w1, B_w2):
    def _A_ref(x, k_cache, v_cache, wq, wo):
        B, Sq, D = x.shape
        Hq, Dh = 16, 256
        Hkv, Sk = k_cache.shape[1], k_cache.shape[2]
        W = min(4096, max(256, Sk // 4))
        rep = Hq // Hkv
        q = (lambda x, *d: x.permute(*d))((x @ wq).reshape(B, Sq, Hq, Dh), 0, 2, 1, 3)
        k = (lambda x, n, axis: torch.repeat_interleave(x, n, dim=axis))(k_cache[:, :, Sk - W:, :], rep, axis=1)
        v = (lambda x, n, axis: torch.repeat_interleave(x, n, dim=axis))(v_cache[:, :, Sk - W:, :], rep, axis=1)
        scores = torch.einsum("bhqd,bhkd->bhqk", q, k) * (Dh ** -0.5)
        p = _softmax(scores, axis=-1)
        o = torch.einsum("bhqk,bhkd->bhqd", p, v)
        return (lambda x, *d: x.permute(*d))(o, 0, 2, 1, 3).reshape(B, Sq, Hq * Dh) @ wo

    def _B_ref(x, w1, w2):
        h = torch.einsum("bsd,df->bsf", x, w1)
        h = _silu(h)
        out = torch.einsum("bsf,fd->bsd", h, w2)
        return out

    x = A_x
    x = x + _A_ref(_layernorm(x, axis=-1), A_k_cache, A_v_cache, A_wq, A_wo)
    x = x + _B_ref(_layernorm(x, axis=-1), B_w1, B_w2)
    x = x + _A_ref(_layernorm(x, axis=-1), A_k_cache, A_v_cache, A_wq, A_wo)
    x = x + _B_ref(_layernorm(x, axis=-1), B_w1, B_w2)
    return x
```

```asm
; @launch grid=(256,1,1) block=(512,1,1) lds=163840
.amdgcn_target "amdgcn-amd-amdhsa--gfx950"
.text
.globl interleave_layers__sliding_block_cached__dense_activation_silu__decode_kernel
.p2align 8
.type interleave_layers__sliding_block_cached__dense_activation_silu__decode_kernel,@function
interleave_layers__sliding_block_cached__dense_activation_silu__decode_kernel:
L_code_ref:
    s_load_dwordx16 s[4:19], s[0:1], 0
    s_load_dwordx4 s[20:23], s[0:1], 64
    s_load_dwordx2 s[24:25], s[0:1], 80
    s_cmpk_ge_u32 s2, 256
    s_cbranch_scc1 L_end
    s_and_b32 s26, s2, 7
    s_lshr_b32 s27, s2, 3
    s_lshl_b32 s26, s26, 2
    s_lshr_b32 s26, 0x24175360, s26
    s_and_b32 s26, s26, 7
    v_lshrrev_b32 v1, 6, v0
    s_getpc_b64 s[98:99]
    v_lshl_add_u32 v254, s27, 3, v1
    v_readfirstlane_b32 s28, v1
    v_and_b32 v254, 127, v254
    v_lshlrev_b32 v254, 7, v254
    global_load_dword v255, v254, s[98:99]

    v_and_b32 v2, 63, v0

    s_cmp_ge_u32 s28, 4
    s_cbranch_scc1 L_comm
    s_lshl_b32 s30, s26, 25
    s_add_u32 s30, s30, 31457280
    s_bfm_b32 s34, 1, 21
    s_bfm_b32 s35, 1, 17
    v_lshrrev_b32 v8, 5, v2
    v_xor_b32 v5, v0, v8
    v_lshlrev_b32 v5, 4, v5
    s_lshl_b32 s60, s27, 12
    s_mul_i32 s61, s28, 16896
    s_mov_b32 m0, s61

    s_mov_b32 s65, s60
    s_waitcnt lgkmcnt(0)
    s_add_u32 s32, s6, s30
    s_addc_u32 s33, s7, 0
    buffer_load_dwordx4 v5, s[32:35], s65 offen nt lds
    s_lshl_b32 s62, s27, 17
    s_min_u32 s62, s62, 3670012
    s_mul_i32 s63, s26, 458752
    s_load_dword s44, s[10:11], s62
    s_load_dword s44, s[12:13], s63
    s_load_dword s44, s[8:9], s30
    s_mov_b32 s29, 4194304
    v_and_b32 v3, 15, v2
    v_lshrrev_b32 v4, 4, v2
    s_mul_i32 s62, s28, 17536
    s_add_u32 s62, s62, 67584
    v_lshlrev_b32 v7, 1, v4
    v_xor_b32 v7, v3, v7
    v_lshlrev_b32 v7, 4, v7
    v_lshl_add_u32 v7, v4, 13, v7
    v_lshlrev_b32 v10, 4, v2
    v_mov_b32 v25, 2147483648
    v_cmp_gt_u32 vcc, 56, v2
    s_nop 1
    v_cndmask_b32 v10, v25, v10, vcc
    s_and_b32 s63, s27, 3
    s_lshl_b32 s63, s63, 8
    s_lshl_b32 s64, s26, 10
    s_add_u32 s63, s63, s64
    s_and_b32 s64, s27, 12
    s_add_u32 s64, s64, s28
    s_lshl_b32 s64, s64, 18
    v_add_u32 v7, s64, v7
    s_lshl_b32 s64, s26, 9
    s_bfe_u32 s66, s27, 0x30001
    s_lshl_b32 s66, s66, 6
    s_add_u32 s64, s64, s66
    s_and_b32 s66, s27, 1
    s_lshl_b32 s66, s66, 3
    s_add_u32 s64, s64, s66
    s_lshl_b32 s66, s28, 4
    s_add_u32 s64, s64, s66
    s_mul_i32 s64, s64, 896
    s_movk_i32 s66, 896
    s_mov_b32 s42, 3670016
    s_mov_b32 s43, 0x20000
    s_cmp_lt_u32 s27, 16
    s_cselect_b32 s40, s10, s12
    s_cselect_b32 s41, s11, s13
    s_cselect_b32 s63, s63, s64
    s_cselect_b32 s64, 32768, s66
    s_cselect_b64 vcc, -1, 0
    v_cndmask_b32 v7, v10, v7, vcc
    s_add_u32 m0, s62, 8704
    s_nop 0
    buffer_load_dwordx4 v7, s[40:43], s63 offen nt lds
    s_add_u32 s63, s63, s64
    s_add_u32 m0, s62, 9792
    s_nop 0
    buffer_load_dwordx4 v7, s[40:43], s63 offen nt lds
    s_add_u32 s63, s63, s64
    s_add_u32 m0, s62, 10880
    s_nop 0
    buffer_load_dwordx4 v7, s[40:43], s63 offen nt lds
    s_add_u32 s63, s63, s64
    s_add_u32 m0, s62, 11968
    s_nop 0
    buffer_load_dwordx4 v7, s[40:43], s63 offen nt lds
    s_add_u32 s63, s63, s64
    s_add_u32 m0, s62, 13056
    s_nop 0
    buffer_load_dwordx4 v7, s[40:43], s63 offen nt lds
    s_add_u32 s63, s63, s64
    s_add_u32 m0, s62, 14144
    s_nop 0
    buffer_load_dwordx4 v7, s[40:43], s63 offen nt lds
    s_add_u32 s63, s63, s64
    s_add_u32 m0, s62, 15232
    s_nop 0
    buffer_load_dwordx4 v7, s[40:43], s63 offen nt lds
    s_add_u32 s63, s63, s64
    s_add_u32 m0, s62, 16320
    s_nop 0
    buffer_load_dwordx4 v7, s[40:43], s63 offen nt lds
    s_add_u32 s63, s63, s64
    s_mov_b32 s40, s4
    s_mov_b32 s41, s5
    s_movk_i32 s42, 896
    s_mov_b32 m0, 148544
    s_nop 0
    buffer_load_dwordx4 v10, s[40:43], 0 offen lds
    s_barrier
    s_add_u32 s36, s8, s30
    s_addc_u32 s37, s9, 0
    s_mov_b32 s38, 0x200000
    s_mov_b32 s39, 0x20000
    v_lshlrev_b32 v9, 1, v8
    v_xor_b32 v6, v2, v9
    v_lshlrev_b32 v6, 4, v6
    v_lshl_add_u32 v6, v1, 10, v6
    v_mov_b32 v12, 0
    v_lshlrev_b32 v13, 2, v1
    v_add_u32 v13, 143424, v13
    v_mov_b32 v26, 143424
    s_lshl_b32 s30, s26, 19
    s_add_u32 s56, s24, s30
    s_addc_u32 s57, s25, 0
    s_mov_b32 s58, 270336
    s_mov_b32 s59, 0x20000
    s_add_u32 s65, s60, 4096
    s_and_b32 s65, s65, 0x1f000
    s_add_u32 s65, s65, 131072
    s_add_u32 m0, s61, 1056
    s_waitcnt vmcnt(8)
    buffer_load_dwordx4 v5, s[32:35], s65 offen nt lds
    s_add_u32 s65, s60, 8192
    s_and_b32 s65, s65, 0x1f000
    s_add_u32 s65, s65, 262144
    s_add_u32 m0, s61, 2112
    s_waitcnt vmcnt(8)
    buffer_load_dwordx4 v5, s[32:35], s65 offen nt lds
    s_add_u32 s65, s60, 12288
    s_and_b32 s65, s65, 0x1f000
    s_add_u32 s65, s65, 393216
    s_add_u32 m0, s61, 3168
    s_waitcnt vmcnt(8)
    buffer_load_dwordx4 v5, s[32:35], s65 offen nt lds
    s_add_u32 s65, s60, 16384
    s_and_b32 s65, s65, 0x1f000
    s_add_u32 s65, s65, 524288
    s_add_u32 m0, s61, 4224
    s_waitcnt vmcnt(8)
    buffer_load_dwordx4 v5, s[32:35], s65 offen nt lds
    s_waitcnt vmcnt(4)
    ds_write_b32 v13, v12 offset:32
    s_add_u32 s65, s60, 20480
    s_and_b32 s65, s65, 0x1f000
    s_add_u32 s65, s65, 655360
    s_add_u32 m0, s61, 5280
    s_waitcnt vmcnt(8)
    buffer_load_dwordx4 v5, s[32:35], s65 offen nt lds
    s_add_u32 s65, s60, 24576
    s_and_b32 s65, s65, 0x1f000
    s_add_u32 s65, s65, 786432
    s_add_u32 m0, s61, 6336
    s_waitcnt vmcnt(8)
    buffer_load_dwordx4 v5, s[32:35], s65 offen nt lds
    s_add_u32 s65, s60, 28672
    s_and_b32 s65, s65, 0x1f000
    s_add_u32 s65, s65, 917504
    s_add_u32 m0, s61, 7392
    s_waitcnt vmcnt(8)
    buffer_load_dwordx4 v5, s[32:35], s65 offen nt lds
    s_add_u32 s65, s60, 32768
    s_and_b32 s65, s65, 0x1f000
    s_add_u32 s65, s65, 1048576
    s_add_u32 m0, s61, 8448
    s_waitcnt vmcnt(8)
    buffer_load_dwordx4 v5, s[32:35], s65 offen nt lds
    v_lshrrev_b32 v14, 1, v3
    v_mul_u32_u24 v14, 1056, v14
    v_and_b32 v15, 1, v3
    v_lshl_add_u32 v14, v15, 9, v14
    v_xor_b32 v15, v4, v15
    v_lshl_add_u32 v14, v15, 4, v14
    v_add_u32 v14, s61, v14
    v_and_b32 v15, 3, v3
    v_bfe_u32 v16, v3, 2, 1
    v_lshl_add_u32 v15, v15, 1, v16
    v_mul_u32_u24 v15, 576, v15
    v_lshl_add_u32 v15, v4, 5, v15
    v_lshrrev_b32 v16, 3, v3
    v_lshl_add_u32 v15, v16, 4, v15
    v_mul_u32_u24 v252, 0xAAAA, v16
    v_add_u32 v252, 0x4444, v252
    v_and_b32 v16, 1, v3
    v_mul_u32_u24 v253, 0xAAAA, v16
    v_add_u32 v253, 0x4444, v253
    v_and_b32 v16, 1, v4
    v_lshlrev_b32 v17, 6, v16
    v_lshl_add_u32 v17, v1, 7, v17
    v_lshrrev_b32 v18, 1, v4
    v_lshl_add_u32 v17, v18, 5, v17
    v_and_b32 v18, 9, v3
    v_lshl_add_u32 v17, v18, 1, v17
    v_and_b32 v18, 2, v3
    v_lshl_add_u32 v17, v18, 2, v17
    v_and_b32 v18, 4, v3
    v_add_u32 v17, v18, v17
    v_lshlrev_b32 v18, 4, v16
    v_lshl_add_u32 v19, v1, 2, v18
    v_bfe_u32 v20, v3, 2, 1
    v_lshlrev_b32 v20, 6, v20
    v_and_b32 v21, 3, v3
    v_lshl_add_u32 v20, v21, 7, v20
    v_lshrrev_b32 v21, 1, v4
    v_lshl_add_u32 v20, v21, 4, v20
    v_and_b32 v21, 2, v4
    v_lshrrev_b32 v22, 3, v3
    v_add_u32 v21, v21, v22
    v_mul_u32_u24 v21, 17536, v21
    v_mul_u32_u24 v22, 1088, v16
    v_add_u32 v21, v21, v22
    v_bfe_u32 v22, v3, 2, 1
    v_lshl_add_u32 v21, v22, 9, v21
    v_and_b32 v23, 3, v3
    v_lshl_add_u32 v21, v23, 3, v21
    v_lshl_add_u32 v21, v1, 7, v21
    v_add_u32 v21, 67584, v21
    v_lshlrev_b32 v23, 5, v22
    v_sub_u32 v22, v21, v23
    v_add_u32 v21, v21, v23
    v_lshlrev_b32 v23, 3, v4
    v_lshl_add_u32 v23, v1, 1, v23
    v_lshrrev_b32 v24, 3, v3
    v_add_u32 v23, v23, v24
    v_lshlrev_b32 v23, 12, v23
    v_and_b32 v24, 7, v3
    v_lshl_add_u32 v23, v24, 4, v23
    s_lshl_b32 s30, s27, 7
    v_add_u32 v23, s30, v23
    v_cmp_gt_u32 vcc, 32, v2
    s_nop 1
    v_cndmask_b32 v23, v25, v23, vcc
    v_lshlrev_b32 v24, 9, v4
    v_lshl_add_u32 v24, v1, 2, v24
    s_lshl_b32 s30, s27, 4
    s_add_u32 s30, s30, 94208
    v_add_u32 v24, s30, v24
    v_add_u32 v19, 143360, v19
    v_lshlrev_b32 v27, 2, v2
    v_add_u32 v27, 144256, v27
    v_and_b32 v28, 47, v2
    v_cmp_eq_u32 vcc, 0, v28
    s_nop 1
    v_cndmask_b32 v24, v25, v24, vcc
    v_cndmask_b32 v19, v27, v19, vcc
    v_add_u32 v15, 137728, v15
    v_add_u32 v17, 142336, v17
    v_add_u32 v18, 143360, v18
    v_add_u32 v20, 142336, v20
    v_mov_b32 v208, 0
    v_mov_b32 v209, 0
    v_mov_b32 v210, 0
    v_mov_b32 v211, 0
    v_mov_b32 v212, 0
    v_mov_b32 v213, 0
    v_mov_b32 v214, 0
    v_mov_b32 v215, 0
    s_add_u32 s65, s60, 36864
    s_and_b32 s65, s65, 0x1f000
    s_add_u32 s65, s65, 1179648
    s_add_u32 m0, s61, 9504
    s_waitcnt vmcnt(8)
    buffer_load_dwordx4 v5, s[32:35], s65 offen nt lds
    s_add_u32 s65, s60, 40960
    s_and_b32 s65, s65, 0x1f000
    s_add_u32 s65, s65, 1310720
    s_add_u32 m0, s61, 10560
    s_waitcnt vmcnt(8)
    buffer_load_dwordx4 v5, s[32:35], s65 offen nt lds
    s_add_u32 s65, s60, 45056
    s_and_b32 s65, s65, 0x1f000
    s_add_u32 s65, s65, 1441792
    s_add_u32 m0, s61, 11616
    s_waitcnt vmcnt(8)
    buffer_load_dwordx4 v5, s[32:35], s65 offen nt lds
    s_add_u32 s65, s60, 49152
    s_and_b32 s65, s65, 0x1f000
    s_add_u32 s65, s65, 1572864
    s_add_u32 m0, s61, 12672
    s_waitcnt vmcnt(8)
    buffer_load_dwordx4 v5, s[32:35], s65 offen nt lds
    s_add_u32 s65, s60, 53248
    s_and_b32 s65, s65, 0x1f000
    s_add_u32 s65, s65, 1703936
    s_add_u32 m0, s61, 13728
    s_waitcnt vmcnt(8)
    buffer_load_dwordx4 v5, s[32:35], s65 offen nt lds
    s_add_u32 s65, s60, 57344
    s_and_b32 s65, s65, 0x1f000
    s_add_u32 s65, s65, 1835008
    s_add_u32 m0, s61, 14784
    s_waitcnt vmcnt(8)
    buffer_load_dwordx4 v5, s[32:35], s65 offen nt lds
    s_add_u32 s65, s60, 61440
    s_and_b32 s65, s65, 0x1f000
    s_add_u32 s65, s65, 1966080
    s_add_u32 m0, s61, 15840
    s_waitcnt vmcnt(8)
    buffer_load_dwordx4 v5, s[32:35], s65 offen nt lds
    s_add_u32 s65, s60, 0
    s_and_b32 s65, s65, 0x1f000
    s_add_u32 s65, s65, 0
    s_add_u32 m0, s62, 0
    s_waitcnt vmcnt(8)
    buffer_load_dwordx4 v6, s[36:39], s65 offen nt lds
    s_add_u32 s65, s60, 4096
    s_and_b32 s65, s65, 0x1f000
    s_add_u32 s65, s65, 131072
    s_add_u32 m0, s62, 1088
    s_waitcnt vmcnt(8)
    buffer_load_dwordx4 v6, s[36:39], s65 offen nt lds
    s_add_u32 s65, s60, 8192
    s_and_b32 s65, s65, 0x1f000
    s_add_u32 s65, s65, 262144
    s_add_u32 m0, s62, 2176
    s_waitcnt vmcnt(8)
    buffer_load_dwordx4 v6, s[36:39], s65 offen nt lds
    s_add_u32 s65, s60, 12288
    s_and_b32 s65, s65, 0x1f000
    s_add_u32 s65, s65, 393216
    s_add_u32 m0, s62, 3264
    s_waitcnt vmcnt(8)
    buffer_load_dwordx4 v6, s[36:39], s65 offen nt lds
    s_add_u32 s65, s60, 16384
    s_and_b32 s65, s65, 0x1f000
    s_add_u32 s65, s65, 524288
    s_add_u32 m0, s62, 4352
    s_waitcnt vmcnt(8)
    buffer_load_dwordx4 v6, s[36:39], s65 offen nt lds
    s_add_u32 s65, s60, 20480
    s_and_b32 s65, s65, 0x1f000
    s_add_u32 s65, s65, 655360
    s_add_u32 m0, s62, 5440
    s_waitcnt vmcnt(8)
    buffer_load_dwordx4 v6, s[36:39], s65 offen nt lds
    s_add_u32 s65, s60, 24576
    s_and_b32 s65, s65, 0x1f000
    s_add_u32 s65, s65, 786432
    s_add_u32 m0, s62, 6528
    s_waitcnt vmcnt(8)
    buffer_load_dwordx4 v6, s[36:39], s65 offen nt lds
    s_add_u32 s65, s60, 28672
    s_and_b32 s65, s65, 0x1f000
    s_add_u32 s65, s65, 917504
    s_add_u32 m0, s62, 7616
    s_waitcnt vmcnt(8)
    buffer_load_dwordx4 v6, s[36:39], s65 offen nt lds
    ds_write_b32 v26, v12 offset:96
    s_waitcnt vmcnt(8)
    ds_read_b128 v[32:35], v14 offset:0
    ds_read_b128 v[36:39], v14 offset:64
    ds_read_b128 v[40:43], v14 offset:128
    ds_read_b128 v[44:47], v14 offset:192
    ds_read_b128 v[48:51], v14 offset:256
    ds_read_b128 v[52:55], v14 offset:320
    ds_read_b128 v[56:59], v14 offset:384
    ds_read_b128 v[60:63], v14 offset:448
    ds_read_b128 v[64:67], v14 offset:8448
    ds_read_b128 v[68:71], v14 offset:8512
    ds_read_b128 v[72:75], v14 offset:8576
    ds_read_b128 v[76:79], v14 offset:8640
    s_waitcnt lgkmcnt(6)
    ds_read_b128 v[80:83], v14 offset:8704
    ds_read_b128 v[84:87], v14 offset:8768
    ds_read_b128 v[88:91], v14 offset:8832
    ds_read_b128 v[92:95], v14 offset:8896
Lw_1:
    ds_read_b128 v[200:203], v26 offset:48
    s_waitcnt lgkmcnt(0)
    v_max3_u32 v200, v200, v201, v202
    v_max_u32 v200, v200, v203
    v_cmp_eq_u32 vcc, -1, v200
    s_cbranch_vccnz Lre_3
Lok_2:
    s_add_u32 s65, s60, 32768
    s_and_b32 s65, s65, 0x1f000
    s_add_u32 s65, s65, 1048576
    s_add_u32 m0, s62, 8704
    s_waitcnt vmcnt(8)
    buffer_load_dwordx4 v6, s[36:39], s65 offen nt lds
    s_add_u32 s65, s60, 36864
    s_and_b32 s65, s65, 0x1f000
    s_add_u32 s65, s65, 1179648
    s_add_u32 m0, s62, 9792
    s_waitcnt vmcnt(8)
    buffer_load_dwordx4 v6, s[36:39], s65 offen nt lds
    s_add_u32 s65, s60, 40960
    s_and_b32 s65, s65, 0x1f000
    s_add_u32 s65, s65, 1310720
    s_add_u32 m0, s62, 10880
    s_waitcnt vmcnt(8)
    buffer_load_dwordx4 v6, s[36:39], s65 offen nt lds
    s_add_u32 s65, s60, 45056
    s_and_b32 s65, s65, 0x1f000
    s_add_u32 s65, s65, 1441792
    s_add_u32 m0, s62, 11968
    s_waitcnt vmcnt(8)
    buffer_load_dwordx4 v6, s[36:39], s65 offen nt lds
    s_add_u32 s65, s60, 49152
    s_and_b32 s65, s65, 0x1f000
    s_add_u32 s65, s65, 1572864
    s_add_u32 m0, s62, 13056
    s_waitcnt vmcnt(8)
    buffer_load_dwordx4 v6, s[36:39], s65 offen nt lds
    s_add_u32 s65, s60, 53248
    s_and_b32 s65, s65, 0x1f000
    s_add_u32 s65, s65, 1703936
    s_add_u32 m0, s62, 14144
    s_waitcnt vmcnt(8)
    buffer_load_dwordx4 v6, s[36:39], s65 offen nt lds
    s_add_u32 s65, s60, 57344
    s_and_b32 s65, s65, 0x1f000
    s_add_u32 s65, s65, 1835008
    s_add_u32 m0, s62, 15232
    s_waitcnt vmcnt(8)
    buffer_load_dwordx4 v6, s[36:39], s65 offen nt lds
    s_add_u32 s65, s60, 61440
    s_and_b32 s65, s65, 0x1f000
    s_add_u32 s65, s65, 1966080
    s_add_u32 m0, s62, 16320
    s_waitcnt vmcnt(8)
    buffer_load_dwordx4 v6, s[36:39], s65 offen nt lds
    s_mov_b32 s94, 13369395
    s_mov_b32 s95, 13369395
    s_mov_b64 s[96:97], -1
    s_mov_b32 s46, 0
    s_mov_b32 s47, 0x3db8aa3b
    s_mov_b32 s48, 0
    s_mov_b32 s50, -1
    s_mov_b32 s51, 0
    s_mov_b32 s49, 0x3b124925
    v_mov_b32 v184, 0x3727c5ac
    v_mov_b32 v11, 143648
    s_waitcnt lgkmcnt(0)
    s_setprio 3
    .p2align 6
L_att_loop:
    v_mov_b32 v192, 0
    v_mov_b32 v193, 0
    v_mov_b32 v194, 0
    v_mov_b32 v195, 0
    v_mov_b32 v196, 0
    v_mov_b32 v197, 0
    v_mov_b32 v198, 0
    v_mov_b32 v199, 0
    v_mov_b32 v224, 0
    v_mov_b32 v225, 0
    v_mov_b32 v226, 0
    v_mov_b32 v227, 0
    v_mov_b32 v228, 0
    v_mov_b32 v229, 0
    v_mov_b32 v230, 0
    v_mov_b32 v231, 0
    v_mov_b32 v232, 0
    v_mov_b32 v233, 0
    v_mov_b32 v234, 0
    v_mov_b32 v235, 0
    v_mov_b32 v236, 0
    v_mov_b32 v237, 0
    v_mov_b32 v238, 0
    v_mov_b32 v239, 0
    s_barrier
    ds_read_b128 v[160:163], v15 offset:0
    ds_read_b32 v200, v26 offset:0
    ds_read_b128 v[164:167], v15 offset:128
    ds_read_b128 v[168:171], v15 offset:256
    ds_read_b128 v[172:175], v15 offset:384
    ds_read_b128 v[176:179], v11
    ds_read_b128 v[180:183], v11 offset:16
    s_waitcnt lgkmcnt(6)
    v_smfmac_f32_16x16x64_bf16 v[192:195], v[160:163], v[32:39], v252
    v_smfmac_f32_16x16x64_bf16 v[196:199], v[160:163], v[64:71], v252
    s_waitcnt lgkmcnt(4)
    v_smfmac_f32_16x16x64_bf16 v[192:195], v[164:167], v[40:47], v252
    v_cmp_eq_u32 vcc, 2, v200
    v_smfmac_f32_16x16x64_bf16 v[196:199], v[164:167], v[72:79], v252
    s_waitcnt lgkmcnt(0)
    v_smfmac_f32_16x16x64_bf16 v[192:195], v[168:171], v[48:55], v252
    s_cbranch_vccnz L_att_slow
    v_smfmac_f32_16x16x64_bf16 v[192:195], v[172:175], v[56:63], v252
    v_pk_add_f32 v[180:181], v[180:181], v[182:183]
    v_pk_add_f32 v[176:177], v[176:177], v[178:179]
    v_smfmac_f32_16x16x64_bf16 v[196:199], v[168:171], v[80:87], v252
    v_add_f32 v180, v180, v181
    v_add_f32 v176, v176, v177
    v_smfmac_f32_16x16x64_bf16 v[196:199], v[172:175], v[88:95], v252
    v_mul_f32 v180, s49, v180
    v_fma_f32 v176, v176, s49, v184
    v_fma_f32 v176, -v180, v180, v176
    v_max_f32 v176, v184, v176
    v_rsq_f32 v176, v176
    s_cmp_eq_u32 s46, 0
    v_pk_add_f32 v[192:193], v[192:193], v[194:195]
    v_add_f32 v192, v192, v193
    v_pk_add_f32 v[196:197], v[196:197], v[198:199]
    v_add_f32 v196, v196, v197
    v_mul_f32 v176, s47, v176
    s_nop 0
    v_permlane32_swap_b32 v192, v196
    v_add_f32 v244, v192, v196
    s_nop 1
    v_max_f32_dpp v245, v244, v244 row_ror:8 row_mask:0xf bank_mask:0xf
    v_mul_f32 v244, v176, v244
    s_nop 0
    v_max_f32_dpp v245, v245, v245 row_ror:4 row_mask:0xf bank_mask:0xf
    s_nop 1
    v_max_f32_dpp v245, v245, v245 row_ror:2 row_mask:0xf bank_mask:0xf
    s_nop 1
    v_max_f32_dpp v245, v245, v245 row_ror:1 row_mask:0xf bank_mask:0xf
    v_mov_b32 v246, v245
    s_nop 1
    v_permlane32_swap_b32 v245, v246
    v_max_f32 v245, v245, v246
    v_fma_f32 v244, -v245, v176, v244
    v_exp_f32 v244, v244
    v_mul_f32 v245, v176, v245
    v_cvt_pk_bf16_f32 v246, v244, v244
    ds_write_b16 v17, v246
    ds_write_b32 v19, v245
    s_cbranch_scc1 Lh_4
    buffer_store_dword v245, v24, s[56:59], s48 offen
Lhb_5:
Lp_9:
    ds_read_b128 v[200:203], v18
    s_mov_b64 exec, s[94:95]
    ds_read_b128 v[208:211], v20
    ds_read_b128 v[212:215], v20 offset:32
    s_mov_b64 exec, s[96:97]
    v_add_f32_dpp v246, v244, v244 row_ror:8 row_mask:0xf bank_mask:0xf
    s_waitcnt lgkmcnt(2)
    v_max3_u32 v205, v200, v201, v202
    v_max_u32 v205, v205, v203
    v_cmp_eq_u32 vcc, -1, v205
    v_max3_f32 v204, v200, v201, v202
    v_max_f32 v204, v204, v203
    s_cmp_eq_u32 s46, 0
    v_sub_f32 v200, v200, v204
    v_sub_f32 v201, v201, v204
    v_sub_f32 v202, v202, v204
    v_sub_f32 v203, v203, v204
    s_waitcnt lgkmcnt(0)
    s_cbranch_vccnz Lre_11
Lok_10:
    v_smfmac_f32_16x16x64_bf16 v[224:227], v[208:211], v[96:103], v253
    v_exp_f32 v200, v200
    v_smfmac_f32_16x16x64_bf16 v[228:231], v[208:211], v[112:119], v253
    v_exp_f32 v201, v201
    v_smfmac_f32_16x16x64_bf16 v[232:235], v[208:211], v[128:135], v253
    v_exp_f32 v202, v202
    v_smfmac_f32_16x16x64_bf16 v[236:239], v[208:211], v[144:151], v253
    v_exp_f32 v203, v203
    s_cbranch_scc1 Lv_12
Lvb_13:
    s_waitcnt lgkmcnt(12)
    v_smfmac_f32_16x16x64_bf16 v[224:227], v[212:215], v[104:111], v253
    s_waitcnt lgkmcnt(8)
    v_smfmac_f32_16x16x64_bf16 v[228:231], v[212:215], v[120:127], v253
    v_add_f32_dpp v246, v246, v246 row_ror:4 row_mask:0xf bank_mask:0xf
    s_waitcnt lgkmcnt(4)
    v_smfmac_f32_16x16x64_bf16 v[232:235], v[212:215], v[136:143], v253
    v_sub_f32 v245, v245, v204
    s_waitcnt lgkmcnt(0)
    v_smfmac_f32_16x16x64_bf16 v[236:239], v[212:215], v[152:159], v253
    v_pk_mul_f32 v[224:225], v[224:225], v[200:201]
    v_pk_fma_f32 v[224:225], v[226:227], v[202:203], v[224:225]
    v_add_f32 v240, v224, v225
    v_pk_mul_f32 v[228:229], v[228:229], v[200:201]
    v_pk_fma_f32 v[228:229], v[230:231], v[202:203], v[228:229]
    v_add_f32 v241, v228, v229
    v_pk_mul_f32 v[232:233], v[232:233], v[200:201]
    v_pk_fma_f32 v[232:233], v[234:235], v[202:203], v[232:233]
    v_add_f32 v242, v232, v233
    v_pk_mul_f32 v[236:237], v[236:237], v[200:201]
    v_pk_fma_f32 v[236:237], v[238:239], v[202:203], v[236:237]
    v_add_f32 v243, v236, v237
    buffer_store_dwordx4 v[240:243], v23, s[56:59], s48 offen
    v_add_f32_dpp v246, v246, v246 row_ror:2 row_mask:0xf bank_mask:0xf
    v_exp_f32 v245, v245
    s_nop 0
    v_add_f32_dpp v246, v246, v246 row_ror:1 row_mask:0xf bank_mask:0xf
    v_mov_b32 v247, v246
    s_nop 1
    v_permlane32_swap_b32 v246, v247
    v_add_f32 v246, v246, v247
    v_mul_f32 v205, v246, v245
    buffer_store_dword v205, v24, s[56:59], s48 offen offset:1024
L_att_join:
    s_cmp_lg_u32 s46, 0
    s_cbranch_scc1 L_att_done
    ds_write_b32 v13, v12 offset:112
    s_mov_b32 s46, 1
    s_mov_b32 s48, 131072
    v_add_u32 v11, 32, v11
    v_add_u32 v17, 512, v17
    v_add_u32 v20, 512, v20
    v_add_u32 v18, 32, v18
    v_add_u32 v19, 32, v19
    s_branch L_att_loop
L_att_done:
    s_endpgm
Lre_3:
    s_sub_u32 s29, s29, 1
    s_cbranch_scc0 Lw_1
    s_mov_b32 s29, 0
    s_branch Lok_2
Lre_8:
    s_sub_u32 s29, s29, 1
    s_cbranch_scc0 Lw_6
    s_mov_b32 s29, 0
    s_branch Lok_7
Lh_4:
    s_waitcnt vmcnt(8)
    ds_write_b32 v13, v12 offset:176
Lw_6:
    ds_read_b128 v[200:203], v26 offset:176
    s_waitcnt lgkmcnt(0)
    v_max3_u32 v200, v200, v201, v202
    v_max_u32 v200, v200, v203
    v_cmp_eq_u32 vcc, -1, v200
    s_cbranch_vccnz Lre_8
Lok_7:
    ds_read_b64_tr_b16 v[96:97], v21 offset:0
    ds_read_b64_tr_b16 v[98:99], v21 offset:2176
    ds_read_b64_tr_b16 v[112:113], v22 offset:32
    ds_read_b64_tr_b16 v[114:115], v22 offset:2208
    ds_read_b64_tr_b16 v[128:129], v21 offset:64
    ds_read_b64_tr_b16 v[130:131], v21 offset:2240
    ds_read_b64_tr_b16 v[144:145], v22 offset:96
    ds_read_b64_tr_b16 v[146:147], v22 offset:2272
    ds_read_b64_tr_b16 v[100:101], v21 offset:4352
    ds_read_b64_tr_b16 v[102:103], v21 offset:6528
    ds_read_b64_tr_b16 v[116:117], v22 offset:4384
    ds_read_b64_tr_b16 v[118:119], v22 offset:6560
    ds_read_b64_tr_b16 v[132:133], v21 offset:4416
    ds_read_b64_tr_b16 v[134:135], v21 offset:6592
    s_waitcnt lgkmcnt(12)
    ds_read_b64_tr_b16 v[148:149], v22 offset:4448
    ds_read_b64_tr_b16 v[150:151], v22 offset:6624
    s_waitcnt lgkmcnt(8)
    s_cmp_eq_u32 s46, 0
    s_branch Lhb_5
Lre_11:
    s_waitcnt lgkmcnt(0)
    s_sub_u32 s29, s29, 1
    s_cbranch_scc0 Lp_9
    s_mov_b32 s29, 0
    s_cmp_eq_u32 s46, 0
    s_branch Lok_10
Lre_16:
    s_sub_u32 s29, s29, 1
    s_cbranch_scc0 Lw_14
    s_mov_b32 s29, 0
    s_branch Lok_15
Lv_12:
    s_waitcnt vmcnt(0)
    ds_write_b32 v13, v12 offset:64
    buffer_store_dword v245, v24, s[56:59], s48 offen
Lw_14:
    ds_read_b128 v[248:251], v26 offset:64
    s_waitcnt lgkmcnt(0)
    v_max3_u32 v248, v248, v249, v250
    v_max_u32 v248, v248, v251
    v_cmp_eq_u32 vcc, -1, v248
    s_cbranch_vccnz Lre_16
Lok_15:
    ds_read_b64_tr_b16 v[104:105], v21 offset:8704
    ds_read_b64_tr_b16 v[106:107], v21 offset:10880
    ds_read_b64_tr_b16 v[108:109], v21 offset:13056
    ds_read_b64_tr_b16 v[110:111], v21 offset:15232
    ds_read_b64_tr_b16 v[120:121], v22 offset:8736
    ds_read_b64_tr_b16 v[122:123], v22 offset:10912
    ds_read_b64_tr_b16 v[124:125], v22 offset:13088
    ds_read_b64_tr_b16 v[126:127], v22 offset:15264
    ds_read_b64_tr_b16 v[136:137], v21 offset:8768
    ds_read_b64_tr_b16 v[138:139], v21 offset:10944
    ds_read_b64_tr_b16 v[140:141], v21 offset:13120
    ds_read_b64_tr_b16 v[142:143], v21 offset:15296
    ds_read_b64_tr_b16 v[152:153], v22 offset:8800
    ds_read_b64_tr_b16 v[154:155], v22 offset:10976
    s_waitcnt lgkmcnt(12)
    ds_read_b64_tr_b16 v[156:157], v22 offset:13152
    ds_read_b64_tr_b16 v[158:159], v22 offset:15328
    s_branch Lvb_13
L_comm:
    s_mov_b32 s29, 4194304
    v_and_b32 v3, 15, v2
    v_lshrrev_b32 v4, 4, v2
    s_setprio 2
    s_sub_u32 s28, s28, 4
    s_lshl_b32 s42, s26, 14
    s_add_u32 s42, s42, 131072
    s_add_u32 s39, s42, 8192
    s_add_u32 s31, s39, 4198400
    s_lshl_b32 s30, s26, 19
    s_add_u32 s30, s30, 0x70000
    s_waitcnt lgkmcnt(0)
    s_load_dword s38, s[24:25], s31
    s_load_dword s36, s[24:25], s30
    s_load_dword s37, s[4:5], 0
    v_and_b32 v1, 3, v1
    v_mov_b32 v40, -1
    v_mov_b32 v41, -1
    v_mov_b32 v42, -1
    v_mov_b32 v43, -1
    v_lshlrev_b32 v12, 4, v2
    s_mov_b32 s62, 524288
    s_mov_b32 s63, 0x20000
    s_add_u32 s60, s24, 4194304
    s_addc_u32 s61, s25, 0
    v_and_b32 v5, 255, v0
    v_lshlrev_b32 v5, 4, v5
    v_add_u32 v6, 137728, v5
    ds_write_b128 v6, v[40:43] offset:0
    ds_write_b128 v6, v[40:43] offset:4096
    ds_write_b128 v6, v[40:43] offset:6656
    v_mov_b32 v25, 2147483648
    s_mov_b32 s64, s4
    s_mov_b32 s65, s5
    s_mov_b32 s66, 896
    s_mov_b32 s67, 0x20000
    v_lshlrev_b32 v35, 1, v3
    v_lshl_add_u32 v35, v4, 5, v35
    v_and_b32 v36, 7, v2
    v_cmp_eq_u32 vcc, 0, v36
    s_nop 1
    v_cndmask_b32 v35, v25, v35, vcc
    s_lshl_b32 s32, s28, 7
    s_lshr_b32 s33, s27, 2
    s_lshl_b32 s33, s33, 8
    v_lshlrev_b32 v9, 2, v2
    s_sub_u32 s34, s27, 16
    s_and_b32 s30, s27, 15
    s_lshl_b32 s30, s30, 7
    v_lshl_add_u32 v27, v3, 3, s30
    v_lshl_add_u32 v27, v4, 1, v27
    v_and_b32 v36, 16, v2
    v_cmp_eq_u32 vcc, 0, v36
    s_nop 1
    v_cndmask_b32 v27, v25, v27, vcc
    v_add_u32 v36, s33, v35
    v_add_u32 v35, s32, v35
    v_cmp_gt_u32 vcc, 32, v2
    s_nop 1
    v_cndmask_b32 v45, v25, v12, vcc
    s_lshl_b32 s30, s27, 9
    s_add_u32 s30, s30, s32
    v_mov_b32 v44, s30
    v_mov_b32 v172, 0
    s_mov_b32 s44, 262144
    s_mov_b32 s52, s22
    s_mov_b32 s53, s23
    s_mov_b32 s54, 256
    s_mov_b32 s55, 0x20000
    s_lshl_b32 s41, s26, 2
    v_mov_b32 v34, 1
    v_cmp_eq_u32 vcc, 0, v2
    s_nop 1
    v_cndmask_b32 v5, v25, v2, vcc
    s_lshl_b32 s30, s26, 19
    s_add_u32 s56, s24, s30
    s_addc_u32 s57, s25, 0
    s_mov_b32 s58, 270336
    s_mov_b32 s59, 0x20000
    s_waitcnt lgkmcnt(0)
    s_barrier
    s_cmp_ge_u32 s27, 16
    s_cbranch_scc1 Lo_19
    buffer_load_dword v176, v44, s[56:59], s44 offen sc1
    s_cmp_lt_u32 s27, 12
    s_cbranch_scc1 Lj_20
    s_lshl_b32 s30, s26, 4
    s_and_b32 s31, s27, 3
    s_lshl_b32 s31, s31, 2
    s_add_u32 s30, s30, s31
    s_add_u32 s30, s30, s28
    s_lshl_b32 s30, s30, 9
    buffer_store_dwordx4 v[40:43], v45, s[60:63], s30 offen sc1
    s_lshl_b32 s30, s27, 14
    s_lshl_b32 s31, s28, 12
    s_add_u32 s30, s30, s31
    buffer_store_dwordx4 v[40:43], v12, s[56:59], s30 offen offset:0
    buffer_store_dwordx4 v[40:43], v12, s[56:59], s30 offen offset:1024
    buffer_store_dwordx4 v[40:43], v12, s[56:59], s30 offen offset:2048
    buffer_store_dwordx4 v[40:43], v12, s[56:59], s30 offen offset:3072
    s_branch Lj_20
Lo_19:
    s_cmp_lg_u32 s26, 0
    s_cbranch_scc1 Lp_21
    s_cmp_lg_u32 s28, 3
    s_cbranch_scc1 Lp_21
    buffer_load_dword v172, v27, s[64:67], 0 offen
    s_load_dword s37, s[20:21], 0
Lp_21:
    s_mul_i32 s30, s34, 12288
    s_mul_i32 s31, s28, 3072
    s_add_u32 s30, s30, s31
    buffer_store_dwordx4 v[40:43], v12, s[56:59], s30 offen offset:0
    buffer_store_dwordx4 v[40:43], v12, s[56:59], s30 offen offset:1024
    buffer_store_dwordx4 v[40:43], v12, s[56:59], s30 offen offset:2048
Lj_20:
    s_mov_b32 s88, 0x00ff00ff
    s_mov_b32 s89, 0x00ff00ff
    s_mov_b32 s45, 0
    v_mov_b32 v187, 0x3727c5ac
    s_mov_b32 s50, -1
    s_mov_b32 s51, 0
    s_mov_b32 s47, 0x3b124925
    s_mov_b32 s46, 0
    s_mov_b32 s48, 0
    s_getreg_b32 s43, hwreg(HW_REG_XCC_ID, 0, 4)
    s_mov_b64 s[94:95], 0
    s_mov_b64 s[96:97], 0
    v_mov_b32 v37, 0
    v_mov_b32 v28, 143424
    v_mov_b32 v29, 143504
    v_lshl_add_u32 v36, v1, 2, v28
    v_lshl_add_u32 v6, v1, 10, v12
    v_lshrrev_b32 v26, 5, v2
    v_lshl_add_u32 v26, v26, 6, v12
    s_mul_i32 s30, s28, 1152
    s_add_u32 s30, s30, 137728
    v_add_u32 v26, s30, v26
    v_min_u32 v31, 24, v9
    s_and_b32 s30, s27, 3
    s_lshl_b32 s30, s30, 7
    s_cmp_ge_u32 s27, 14
    s_cselect_b32 s30, 512, s30
    s_add_u32 s30, s30, 96256
    v_add_u32 v31, s30, v31
    v_mov_b32 v7, v25
    v_mov_b32 v8, v25
    v_mov_b32 v13, v25
    v_mov_b32 v14, v25
    v_mov_b32 v15, v25
    v_mov_b32 v16, v25
    v_mov_b32 v17, v25
    v_mov_b32 v18, v25
    v_mov_b32 v19, v25
    v_mov_b32 v22, v25
    v_mov_b32 v23, v25
    v_mov_b32 v24, v25
    v_mov_b32 v30, v25
    v_mov_b32 v46, v25
    v_mov_b32 v182, v25
    v_mov_b32 v177, v25
    v_mov_b32 v181, v25
    v_and_b32 v38, 7, v3
    v_lshlrev_b32 v38, 7, v38
    v_lshrrev_b32 v21, 3, v3
    v_lshl_add_u32 v38, v21, 4, v38
    v_lshl_add_u32 v38, v4, 5, v38
    v_mul_u32_u24 v183, 0xAAAA, v21
    v_add_u32 v183, 0x4444, v183
    v_lshl_add_u32 v20, v1, 10, v38
    v_add_u32 v21, 4096, v20
    v_cmp_gt_u32 vcc, 3, v1
    s_nop 1
    v_cndmask_b32 v21, v25, v21, vcc
    v_lshlrev_b32 v240, 1, v3
    v_lshl_add_u32 v240, v1, 2, v240
    v_add_u32 v240, 143648, v240
    v_add_u32 v241, 144768, v9
    v_and_b32 v242, 55, v2
    v_cmp_eq_u32 vcc, 0, v242
    s_nop 1
    v_cndmask_b32 v240, v241, v240, vcc
    v_mov_b32 v241, 0x42dfff6d
    v_cndmask_b32 v241, 0, v241, s[88:89]
    ds_write_b32 v240, v241
    v_mov_b32 v144, 0x3f803f80
    v_mov_b32 v145, v144
    v_mov_b32 v146, v144
    v_mov_b32 v147, v144
    s_cmp_ge_u32 s27, 16
    s_cbranch_scc1 L_orole
    s_mov_b32 s49, 0
    s_lshl_b32 s30, s33, 3
    v_add_u32 v22, s30, v38
    v_add_u32 v23, 1024, v22
    s_cmp_lt_u32 s27, 12
    s_cselect_b64 vcc, -1, 0
    v_cndmask_b32 v23, v25, v23, vcc
    s_and_b32 s30, s27, 3
    s_lshl_b32 s30, s30, 10
    v_lshlrev_b32 v181, 8, v1
    v_lshl_add_u32 v181, v3, 3, v181
    v_add_u32 v181, s30, v181
    s_lshl_b32 s30, s33, 4
    v_lshl_add_u32 v180, v4, 6, v181
    v_add_u32 v180, s30, v180
    v_and_b32 v35, 16, v2
    v_cmp_eq_u32 vcc, 0, v35
    s_nop 1
    v_cndmask_b32 v180, v25, v180, vcc
    v_lshl_add_u32 v181, v4, 12, v181
    s_lshl_b32 s45, s26, 14
    s_add_u32 s45, s45, 393216
    s_lshl_b32 s30, s27, 4
    s_lshl_b32 s31, s28, 2
    s_add_u32 s30, s30, s31
    s_add_u32 s30, s30, 97024
    v_add_u32 v19, s30, v5
    v_lshlrev_b32 v30, 4, v3
    v_lshlrev_b32 v32, 1, v3
    v_add_u32 v32, 256, v32
    v_cmp_gt_u32 vcc, 16, v2
    s_nop 1
    v_cndmask_b32 v32, v32, v30, vcc
    v_lshl_add_u32 v32, v1, 2, v32
    v_and_b32 v33, 55, v2
    v_cmp_eq_u32 s[30:31], 32, v33
    s_or_b64 vcc, vcc, s[30:31]
    v_add_u32 v33, 288, v9
    v_cndmask_b32 v33, v33, v32, vcc
    v_add_u32 v32, 145280, v30
    v_add_u32 v30, 145280, v33
    v_mov_b32 v33, 145536
    v_lshrrev_b32 v24, 1, v4
    v_lshlrev_b32 v24, 5, v24
    v_and_b32 v35, 2, v3
    v_lshl_add_u32 v24, v35, 3, v24
    v_and_b32 v35, 12, v3
    v_add_u32 v24, v35, v24
    v_lshl_add_u32 v24, v1, 6, v24
    s_lshl_b32 s30, s27, 8
    v_add_u32 v24, s30, v24
    v_and_b32 v35, 17, v2
    v_cmp_eq_u32 vcc, 0, v35
    s_nop 1
    v_cndmask_b32 v24, v25, v24, vcc
    v_lshrrev_b32 v18, 5, v2
    v_lshl_add_u32 v18, v1, 1, v18
    v_cmp_gt_u32 vcc, 7, v18
    v_lshlrev_b32 v18, 12, v18
    v_and_b32 v35, 31, v2
    v_lshl_add_u32 v18, v35, 3, v18
    v_add_u32 v18, s30, v18
    v_cndmask_b32 v18, v25, v18, vcc
    v_lshrrev_b32 v14, 2, v3
    v_lshlrev_b32 v15, 1, v1
    v_xor_b32 v15, v15, v14
    v_lshlrev_b32 v13, 8, v14
    v_mul_u32_u24 v16, 2176, v4
    v_add_u32 v13, v13, v16
    v_and_b32 v16, 3, v3
    v_lshl_add_u32 v13, v16, 3, v13
    v_add_u32 v13, 76288, v13
    v_xor_b32 v14, 1, v15
    v_lshl_add_u32 v14, v14, 5, v13
    v_lshl_add_u32 v13, v15, 5, v13
    s_cmp_lt_u32 s27, 12
    s_cbranch_scc1 Lw_22
    s_waitcnt vmcnt(0)
Lw_22:
    s_mul_i32 s30, s38, 0x9E3779B1
    s_add_u32 s30, s30, 0x7F4A7C15
    v_mov_b32 v175, s30
    ds_write_b32 v36, v37 offset:144
    s_cmp_lg_u32 s28, 0
    s_cbranch_scc1 Lnw_23
Lw_25:
    ds_read_b128 v[44:47], v28 offset:144
    s_waitcnt lgkmcnt(0)
    v_max3_u32 v44, v44, v45, v46
    v_max_u32 v44, v44, v47
    v_cmp_eq_u32 vcc, -1, v44
    s_cbranch_vccnz Lre_27
Lok_26:
    v_mov_b32 v174, s43
    s_lshl_b32 s30, s27, 5
    s_add_u32 s30, s30, s39
    buffer_store_dwordx2 v[174:175], v5, s[60:63], s30 offen sc1
Lnw_23:
    v_mov_b32 v48, 0
    v_mov_b32 v49, 0
    v_mov_b32 v50, 0
    v_mov_b32 v51, 0
    v_mov_b32 v52, 0
    v_mov_b32 v53, 0
    v_mov_b32 v54, 0
    v_mov_b32 v55, 0
    v_mov_b32 v56, 0
    v_mov_b32 v57, 0
    v_mov_b32 v58, 0
    v_mov_b32 v59, 0
    v_mov_b32 v60, 0
    v_mov_b32 v61, 0
    v_mov_b32 v62, 0
    v_mov_b32 v63, 0
    v_lshrrev_b32 v16, 1, v3
    v_lshl_add_u32 v16, v4, 5, v16
    v_add_u32 v16, 148544, v16
    v_add_u32 v17, s33, v16
    v_add_u32 v16, s32, v16
Lw_28:
    ds_read_b128 v[44:47], v28 offset:32
    s_waitcnt lgkmcnt(0)
    v_max3_u32 v44, v44, v45, v46
    v_max_u32 v44, v44, v47
    v_cmp_eq_u32 vcc, -1, v44
    s_cbranch_vccnz Lre_30
Lok_29:
    s_mov_b32 exec_lo, 0x01010101
    s_mov_b32 exec_hi, 0x01010101
    ds_read2_b32 v[48:49], v16 offset0:0 offset1:2
    ds_read2_b32 v[50:51], v16 offset0:4 offset1:6
    ds_read2_b32 v[52:53], v16 offset0:128 offset1:130
    ds_read2_b32 v[54:55], v16 offset0:132 offset1:134
    ds_read2_b32 v[56:57], v17 offset0:0 offset1:2
    ds_read2_b32 v[58:59], v17 offset0:4 offset1:6
    ds_read2_b32 v[60:61], v17 offset0:32 offset1:34
    ds_read2_b32 v[62:63], v17 offset0:36 offset1:38
    s_mov_b64 exec, -1
    s_waitcnt lgkmcnt(4)
    ds_read_b64_tr_b16 v[64:65], v13 offset:0
    ds_read_b64_tr_b16 v[66:67], v13 offset:1088
    ds_read_b64_tr_b16 v[68:69], v13 offset:17536
    ds_read_b64_tr_b16 v[70:71], v13 offset:18624
    s_waitcnt lgkmcnt(4)
    ds_read_b64_tr_b16 v[72:73], v13 offset:35072
    ds_read_b64_tr_b16 v[74:75], v13 offset:36160
    ds_read_b64_tr_b16 v[76:77], v13 offset:52608
    ds_read_b64_tr_b16 v[78:79], v13 offset:53696
    s_waitcnt lgkmcnt(4)
    ds_read_b64_tr_b16 v[80:81], v14 offset:0
    ds_read_b64_tr_b16 v[82:83], v14 offset:1088
    ds_read_b64_tr_b16 v[84:85], v14 offset:17536
    ds_read_b64_tr_b16 v[86:87], v14 offset:18624
    s_waitcnt lgkmcnt(4)
    ds_read_b64_tr_b16 v[88:89], v14 offset:35072
    ds_read_b64_tr_b16 v[90:91], v14 offset:36160
    ds_read_b64_tr_b16 v[92:93], v14 offset:52608
    ds_read_b64_tr_b16 v[94:95], v14 offset:53696
    s_waitcnt lgkmcnt(4)
    s_waitcnt lgkmcnt(0)
    ds_write_b32 v36, v37 offset:48
    s_cmp_lt_u32 s27, 12
    s_cbranch_scc1 Lz_31
    v_mov_b32 v72, 0
    v_mov_b32 v73, 0
    v_mov_b32 v74, 0
    v_mov_b32 v75, 0
    v_mov_b32 v76, 0
    v_mov_b32 v77, 0
    v_mov_b32 v78, 0
    v_mov_b32 v79, 0
    v_mov_b32 v88, 0
    v_mov_b32 v89, 0
    v_mov_b32 v90, 0
    v_mov_b32 v91, 0
    v_mov_b32 v92, 0
    v_mov_b32 v93, 0
    v_mov_b32 v94, 0
    v_mov_b32 v95, 0
Lz_31:
    v_mfma_f32_16x16x32_bf16 v[156:159], v[144:147], v[64:67], 0
    v_mfma_f32_16x16x32_bf16 v[160:163], v[144:147], v[80:83], 0
    v_mfma_f32_16x16x32_bf16 v[156:159], v[144:147], v[68:71], v[156:159]
    v_mfma_f32_16x16x32_bf16 v[160:163], v[144:147], v[84:87], v[160:163]
    v_mfma_f32_16x16x32_bf16 v[156:159], v[144:147], v[72:75], v[156:159]
    v_mfma_f32_16x16x32_bf16 v[160:163], v[144:147], v[88:91], v[160:163]
    v_mfma_f32_16x16x32_bf16 v[156:159], v[144:147], v[76:79], v[156:159]
    v_mfma_f32_16x16x32_bf16 v[160:163], v[144:147], v[92:95], v[160:163]
    s_nop 7
    v_cndmask_b32 v38, v160, v156, s[50:51]
    v_mov_b32 v39, v175
    s_call_b64 s[90:91], L_qs_body
    v_add_u32 v30, 640, v30
    v_add_u32 v32, 640, v32
    v_add_u32 v33, 640, v33
    v_mov_b32 v178, v42
    v_mov_b32 v179, v175
    v_lshlrev_b32 v177, 1, v24
    v_max_u32 v177, v177, v24
    buffer_store_dwordx2 v[178:179], v177, s[56:59], s44 offen
    buffer_store_dwordx2 v[38:39], v180, s[60:63], s45 offen sc1
    s_branch L_rec
Lre_27:
    s_sub_u32 s29, s29, 1
    s_cbranch_scc0 Lw_25
    s_mov_b32 s29, 0
    s_branch Lok_26
Lre_30:
    s_sub_u32 s29, s29, 1
    s_cbranch_scc0 Lw_28
    s_mov_b32 s29, 0
    s_branch Lok_29
    .p2align 6
L_qs_poll:
L_qs_body:
    v_mov_b32 v156, 0
    v_mov_b32 v157, 0
    v_mov_b32 v158, 0
    v_mov_b32 v159, 0
    v_mov_b32 v160, 0
    v_mov_b32 v161, 0
    v_mov_b32 v162, 0
    v_mov_b32 v163, 0
    v_mfma_f32_16x16x32_bf16 v[148:151], v[48:51], v[48:51], 0
    v_mfma_f32_16x16x32_bf16 v[152:155], v[48:51], v[144:147], 0
    v_mfma_f32_16x16x32_bf16 v[148:151], v[52:55], v[52:55], v[148:151]
    v_mfma_f32_16x16x32_bf16 v[152:155], v[52:55], v[144:147], v[152:155]
    v_smfmac_f32_16x16x64_bf16 v[156:159], v[56:59], v[64:71], v183
    v_smfmac_f32_16x16x64_bf16 v[160:163], v[56:59], v[80:87], v183
    v_smfmac_f32_16x16x64_bf16 v[156:159], v[60:63], v[72:79], v183
    v_smfmac_f32_16x16x64_bf16 v[160:163], v[60:63], v[88:95], v183
    s_nop 2
    v_pk_add_f32 v[40:41], v[148:149], v[150:151]
    v_pk_add_f32 v[42:43], v[152:153], v[154:155]
    v_add_f32 v40, v40, v41
    v_add_f32 v42, v42, v43
    s_nop 0
    v_add_f32_dpp v40, v40, v40 quad_perm:[1,0,3,2] row_mask:0xf bank_mask:0xf
    s_nop 0
    s_nop 0
    v_add_f32_dpp v40, v40, v40 quad_perm:[2,3,0,1] row_mask:0xf bank_mask:0xf
    v_pk_add_f32 v[156:157], v[156:157], v[158:159]
    v_pk_add_f32 v[160:161], v[160:161], v[162:163]
    v_add_f32_dpp v40, v40, v40 row_half_mirror row_mask:0xf bank_mask:0xf
    v_add_f32 v156, v156, v157
    v_add_f32 v160, v160, v161
    v_mov_b32_dpp v40, v40 row_ror:8 row_mask:0xc bank_mask:0xf
    v_cndmask_b32 v41, v42, v40, s[88:89]
    v_cndmask_b32 v40, v42, v40, s[88:89]
    v_permlane32_swap_b32 v156, v160
    v_add_f32 v44, v156, v160
    v_permlane32_swap_b32 v40, v41
    v_add_f32 v42, v40, v41
    v_add_f32 v40, v40, v41
    v_add_f32 v46, v156, v160
    s_nop 0
    v_permlane16_swap_b32 v40, v42
    v_add_f32 v40, v40, v42
    ds_write_b32 v30, v40
    ds_read_b128 v[152:155], v33 offset:16
    ds_read_b128 v[148:151], v33
    v_permlane16_swap_b32 v44, v46
    v_add_f32 v44, v44, v46
Ls_32:
    s_waitcnt lgkmcnt(1)
    v_pk_add_f32 v[152:153], v[152:153], v[154:155]
    s_waitcnt lgkmcnt(0)
    v_pk_add_f32 v[148:149], v[148:149], v[150:151]
    v_add_f32 v152, v152, v153
    v_add_f32 v148, v148, v149
    v_mul_f32 v42, s47, v152
    v_fma_f32 v43, v148, s47, v187
    v_max_u32 v45, v148, v152
    v_fma_f32 v43, -v42, v42, v43
    v_cmp_eq_u32 vcc, -1, v45
    v_max_f32 v43, v187, v43
    v_rsq_f32 v43, v43
    v_fma_f32 v41, -v42, v38, v44
    v_mul_f32 v41, v41, v43
    s_nop 1
    v_mov_b32_dpp v42, v41 quad_perm:[1,0,3,2] row_mask:0xf bank_mask:0xf
    v_cvt_pk_bf16_f32 v42, v41, v42
    s_cbranch_vccnz Lre_34
Lok_33:
    s_setpc_b64 s[90:91]
Lre_34:
    ds_read_b128 v[152:155], v33 offset:16
    ds_read_b128 v[148:151], v33
    s_sub_u32 s29, s29, 1
    s_cbranch_scc0 Ls_32
    s_mov_b32 s29, 0
    s_waitcnt lgkmcnt(0)
    s_branch Lok_33
L_centre:
Lcs_35:
    v_xor_b32 v40, v221, v175
    v_xor_b32 v41, v223, v175
    v_or_b32 v40, v40, v41
    v_cmp_ne_u32 vcc, 0, v40
    s_cbranch_vccnz Lre_37
Lok_36:
    v_mov_b32 v221, v220
    s_nop 1
    v_permlane32_swap_b32 v220, v221
    v_add_f32 v220, v220, v221
    v_mov_b32 v221, v220
    s_nop 1
    v_permlane16_swap_b32 v220, v221
    v_add_f32 v220, v220, v221
    v_mul_f32 v220, s47, v220
    v_mov_b32 v223, v222
    s_nop 1
    v_permlane32_swap_b32 v222, v223
    v_add_f32 v222, v222, v223
    v_mov_b32 v223, v222
    s_nop 1
    v_permlane16_swap_b32 v222, v223
    v_add_f32 v222, v222, v223
    v_mul_f32 v222, s47, v222
    v_lshlrev_b32 v40, 16, v64
    v_and_b32 v41, 0xffff0000, v64
    v_sub_f32 v40, v40, v220
    v_sub_f32 v41, v41, v220
    v_cvt_pk_bf16_f32 v64, v40, v41
    v_lshlrev_b32 v40, 16, v65
    v_and_b32 v41, 0xffff0000, v65
    v_sub_f32 v40, v40, v220
    v_sub_f32 v41, v41, v220
    v_cvt_pk_bf16_f32 v65, v40, v41
    v_lshlrev_b32 v40, 16, v66
    v_and_b32 v41, 0xffff0000, v66
    v_sub_f32 v40, v40, v220
    v_sub_f32 v41, v41, v220
    v_cvt_pk_bf16_f32 v66, v40, v41
    v_lshlrev_b32 v40, 16, v67
    v_and_b32 v41, 0xffff0000, v67
    v_sub_f32 v40, v40, v220
    v_sub_f32 v41, v41, v220
    v_cvt_pk_bf16_f32 v67, v40, v41
    v_lshlrev_b32 v40, 16, v68
    v_and_b32 v41, 0xffff0000, v68
    v_sub_f32 v40, v40, v220
    v_sub_f32 v41, v41, v220
    v_cvt_pk_bf16_f32 v68, v40, v41
    v_lshlrev_b32 v40, 16, v69
    v_and_b32 v41, 0xffff0000, v69
    v_sub_f32 v40, v40, v220
    v_sub_f32 v41, v41, v220
    v_cvt_pk_bf16_f32 v69, v40, v41
    v_lshlrev_b32 v40, 16, v70
    v_and_b32 v41, 0xffff0000, v70
    v_sub_f32 v40, v40, v220
    v_sub_f32 v41, v41, v220
    v_cvt_pk_bf16_f32 v70, v40, v41
    v_lshlrev_b32 v40, 16, v71
    v_and_b32 v41, 0xffff0000, v71
    v_sub_f32 v40, v40, v220
    v_sub_f32 v41, v41, v220
    v_cvt_pk_bf16_f32 v71, v40, v41
    v_lshlrev_b32 v40, 16, v72
    v_and_b32 v41, 0xffff0000, v72
    v_sub_f32 v40, v40, v220
    v_sub_f32 v41, v41, v220
    v_cvt_pk_bf16_f32 v72, v40, v41
    v_lshlrev_b32 v40, 16, v73
    v_and_b32 v41, 0xffff0000, v73
    v_sub_f32 v40, v40, v220
    v_sub_f32 v41, v41, v220
    v_cvt_pk_bf16_f32 v73, v40, v41
    v_lshlrev_b32 v40, 16, v74
    v_and_b32 v41, 0xffff0000, v74
    v_sub_f32 v40, v40, v220
    v_sub_f32 v41, v41, v220
    v_cvt_pk_bf16_f32 v74, v40, v41
    v_lshlrev_b32 v40, 16, v75
    v_and_b32 v41, 0xffff0000, v75
    v_sub_f32 v40, v40, v220
    v_sub_f32 v41, v41, v220
    v_cvt_pk_bf16_f32 v75, v40, v41
    v_lshlrev_b32 v40, 16, v76
    v_and_b32 v41, 0xffff0000, v76
    v_sub_f32 v40, v40, v220
    v_sub_f32 v41, v41, v220
    v_cvt_pk_bf16_f32 v76, v40, v41
    v_lshlrev_b32 v40, 16, v77
    v_and_b32 v41, 0xffff0000, v77
    v_sub_f32 v40, v40, v220
    v_sub_f32 v41, v41, v220
    v_cvt_pk_bf16_f32 v77, v40, v41
    v_lshlrev_b32 v40, 16, v78
    v_and_b32 v41, 0xffff0000, v78
    v_sub_f32 v40, v40, v220
    v_sub_f32 v41, v41, v220
    v_cvt_pk_bf16_f32 v78, v40, v41
    v_lshlrev_b32 v40, 16, v79
    v_and_b32 v41, 0xffff0000, v79
    v_sub_f32 v40, v40, v220
    v_sub_f32 v41, v41, v220
    v_cvt_pk_bf16_f32 v79, v40, v41
    v_lshlrev_b32 v40, 16, v80
    v_and_b32 v41, 0xffff0000, v80
    v_sub_f32 v40, v40, v222
    v_sub_f32 v41, v41, v222
    v_cvt_pk_bf16_f32 v80, v40, v41
    v_lshlrev_b32 v40, 16, v81
    v_and_b32 v41, 0xffff0000, v81
    v_sub_f32 v40, v40, v222
    v_sub_f32 v41, v41, v222
    v_cvt_pk_bf16_f32 v81, v40, v41
    v_lshlrev_b32 v40, 16, v82
    v_and_b32 v41, 0xffff0000, v82
    v_sub_f32 v40, v40, v222
    v_sub_f32 v41, v41, v222
    v_cvt_pk_bf16_f32 v82, v40, v41
    v_lshlrev_b32 v40, 16, v83
    v_and_b32 v41, 0xffff0000, v83
    v_sub_f32 v40, v40, v222
    v_sub_f32 v41, v41, v222
    v_cvt_pk_bf16_f32 v83, v40, v41
    v_lshlrev_b32 v40, 16, v84
    v_and_b32 v41, 0xffff0000, v84
    v_sub_f32 v40, v40, v222
    v_sub_f32 v41, v41, v222
    v_cvt_pk_bf16_f32 v84, v40, v41
    v_lshlrev_b32 v40, 16, v85
    v_and_b32 v41, 0xffff0000, v85
    v_sub_f32 v40, v40, v222
    v_sub_f32 v41, v41, v222
    v_cvt_pk_bf16_f32 v85, v40, v41
    v_lshlrev_b32 v40, 16, v86
    v_and_b32 v41, 0xffff0000, v86
    v_sub_f32 v40, v40, v222
    v_sub_f32 v41, v41, v222
    v_cvt_pk_bf16_f32 v86, v40, v41
    v_lshlrev_b32 v40, 16, v87
    v_and_b32 v41, 0xffff0000, v87
    v_sub_f32 v40, v40, v222
    v_sub_f32 v41, v41, v222
    v_cvt_pk_bf16_f32 v87, v40, v41
    v_lshlrev_b32 v40, 16, v88
    v_and_b32 v41, 0xffff0000, v88
    v_sub_f32 v40, v40, v222
    v_sub_f32 v41, v41, v222
    v_cvt_pk_bf16_f32 v88, v40, v41
    v_lshlrev_b32 v40, 16, v89
    v_and_b32 v41, 0xffff0000, v89
    v_sub_f32 v40, v40, v222
    v_sub_f32 v41, v41, v222
    v_cvt_pk_bf16_f32 v89, v40, v41
    v_lshlrev_b32 v40, 16, v90
    v_and_b32 v41, 0xffff0000, v90
    v_sub_f32 v40, v40, v222
    v_sub_f32 v41, v41, v222
    v_cvt_pk_bf16_f32 v90, v40, v41
    v_lshlrev_b32 v40, 16, v91
    v_and_b32 v41, 0xffff0000, v91
    v_sub_f32 v40, v40, v222
    v_sub_f32 v41, v41, v222
    v_cvt_pk_bf16_f32 v91, v40, v41
    v_lshlrev_b32 v40, 16, v92
    v_and_b32 v41, 0xffff0000, v92
    v_sub_f32 v40, v40, v222
    v_sub_f32 v41, v41, v222
    v_cvt_pk_bf16_f32 v92, v40, v41
    v_lshlrev_b32 v40, 16, v93
    v_and_b32 v41, 0xffff0000, v93
    v_sub_f32 v40, v40, v222
    v_sub_f32 v41, v41, v222
    v_cvt_pk_bf16_f32 v93, v40, v41
    v_lshlrev_b32 v40, 16, v94
    v_and_b32 v41, 0xffff0000, v94
    v_sub_f32 v40, v40, v222
    v_sub_f32 v41, v41, v222
    v_cvt_pk_bf16_f32 v94, v40, v41
    v_lshlrev_b32 v40, 16, v95
    v_and_b32 v41, 0xffff0000, v95
    v_sub_f32 v40, v40, v222
    v_sub_f32 v41, v41, v222
    v_cvt_pk_bf16_f32 v95, v40, v41
    s_setpc_b64 s[90:91]
Lre_37:
    buffer_load_dwordx2 v[220:221], v181, s[60:63], s45 offen sc1
    buffer_load_dwordx2 v[222:223], v181, s[60:63], s45 offen offset:128 sc1
    s_waitcnt vmcnt(0)
    s_sub_u32 s29, s29, 1
    s_cbranch_scc0 Lcs_35
    s_mov_b32 s29, 0
    s_branch Lok_36
L_orole:
    v_and_b32 v35, 7, v2
    v_lshl_add_u32 v8, v1, 3, v35
    s_lshr_b32 s30, s34, 3
    s_lshl_b32 s30, s30, 9
    s_add_u32 s30, s30, 94208
    v_lshlrev_b32 v15, 7, v8
    v_and_b32 v7, 31, v2
    v_lshlrev_b32 v8, 3, v1
    v_xor_b32 v7, v7, v8
    v_lshl_add_u32 v7, v7, 4, s30
    v_lshrrev_b32 v10, 3, v2
    v_lshl_add_u32 v15, v10, 4, v15
    s_lshl_b32 s30, s34, 12
    v_add_u32 v15, s30, v15
    v_add_u32 v13, s30, v12
    v_cmp_gt_u32 vcc, 32, v2
    s_nop 1
    v_cndmask_b32 v14, v25, v13, vcc
    v_lshlrev_b32 v10, 3, v10
    v_lshl_add_u32 v10, v1, 6, v10
    v_add_u32 v10, 143744, v10
    v_lshlrev_b32 v11, 3, v2
    v_add_u32 v11, 144512, v11
    v_cmp_eq_u32 vcc, 0, v35
    s_nop 1
    v_cndmask_b32 v10, v11, v10, vcc
    v_and_b32 v11, 3, v2
    v_lshlrev_b32 v11, 6, v11
    v_bfe_u32 v16, v2, 2, 3
    v_lshl_add_u32 v11, v16, 3, v11
    v_add_u32 v11, 143744, v11
    s_lshl_b32 s30, s34, 8
    v_lshl_add_u32 v16, v1, 13, v9
    v_add_u32 v16, s30, v16
    v_add_u32 v17, 4096, v16
    v_cmp_gt_u32 vcc, 3, v1
    s_nop 1
    v_cndmask_b32 v17, v25, v17, vcc
    v_lshrrev_b32 v35, 2, v3
    v_lshlrev_b32 v35, 5, v35
    v_and_b32 v33, 3, v3
    v_lshl_add_u32 v35, v33, 2, v35
    v_lshrrev_b32 v33, 1, v4
    v_lshl_add_u32 v35, v33, 4, v35
    v_and_b32 v33, 1, v4
    s_lshl_b32 s30, s34, 10
    v_add_u32 v35, s30, v35
    v_lshl_add_u32 v23, v33, 7, v35
    s_cmp_eq_u32 s26, 0
    s_cselect_b64 vcc, -1, 0
    v_cndmask_b32 v23, v25, v23, vcc
    v_cmp_eq_u32 vcc, 1, v33
    s_nop 1
    v_cndmask_b32 v22, v25, v23, vcc
    s_lshl_b32 s31, s26, 7
    v_lshl_add_u32 v19, v33, 13, v35
    v_add_u32 v19, s31, v19
    s_lshl_b32 s30, s34, 2
    s_add_u32 s30, s30, 96256
    v_lshl_add_u32 v30, v2, 7, s30
    v_cmp_gt_u32 vcc, 5, v2
    s_nop 1
    v_cndmask_b32 v30, v25, v30, vcc
    v_mov_b32 v32, 143360
    v_lshrrev_b32 v33, 2, v3
    v_mul_u32_u24 v33, 17536, v33
    v_and_b32 v35, 3, v3
    v_lshl_add_u32 v33, v35, 3, v33
    v_lshl_add_u32 v33, v4, 5, v33
    v_lshl_add_u32 v33, v1, 8, v33
    v_add_u32 v33, 76288, v33
    s_mov_b32 s49, 0
    s_cmp_lt_u32 s34, 7
    s_cselect_b32 s3, 3, 9
    s_mov_b32 s64, s20
    s_mov_b32 s65, s21
    s_mov_b32 s35, 0
    s_waitcnt vmcnt(0)
    s_cmp_eq_u32 s26, 0
    s_cselect_b32 s92, 0xffff, 0
    s_mov_b32 s93, s92
    s_cselect_b32 s30, -1, 0
    v_and_b32 v172, s30, v172
    v_lshlrev_b32 v176, 16, v172
    v_and_b32 v177, 0xffff0000, v172
    s_waitcnt lgkmcnt(0)
    s_mul_i32 s30, s38, 0x9E3779B1
    s_add_u32 s30, s30, 0x7F4A7C15
    v_mov_b32 v175, s30
    ds_write_b32 v36, v37 offset:144
    s_cmp_lg_u32 s28, 0
    s_cbranch_scc1 Lnw_38
Lw_40:
    ds_read_b128 v[44:47], v28 offset:144
    s_waitcnt lgkmcnt(0)
    v_max3_u32 v44, v44, v45, v46
    v_max_u32 v44, v44, v47
    v_cmp_eq_u32 vcc, -1, v44
    s_cbranch_vccnz Lre_42
Lok_41:
    v_mov_b32 v174, s43
    s_lshl_b32 s30, s27, 5
    s_add_u32 s30, s30, s39
    buffer_store_dwordx2 v[174:175], v5, s[60:63], s30 offen sc1
    s_branch Lnw_39
Lnw_38:
    s_cmp_gt_u32 s28, 1
    s_cbranch_scc1 Lnw_39
    s_cmp_lt_u32 s34, 8
    s_cbranch_scc1 Lnw_39
    s_lshl_b32 s31, s34, 2
    s_add_u32 s40, s31, s28
    s_lshl_b32 s30, s40, 7
    s_lshl_b32 s31, s26, 14
    s_add_u32 s30, s30, s31
    s_add_u32 s33, s34, s28
    s_and_b32 s33, s33, 1
    s_lshl_b32 s31, s33, 13
    s_add_u32 s31, s31, 262144
    s_add_u32 s31, s31, s30
    s_add_u32 s8, s60, s31
    s_addc_u32 s9, s61, 0
    s_xor_b32 s31, s31, 0x2000
    s_add_u32 s4, s60, s31
    s_addc_u32 s5, s61, 0
    s_load_dword s10, s[8:9], 0 glc
    s_load_dword s11, s[4:5], 0 glc
    s_waitcnt lgkmcnt(0)
    s_memtime s[12:13]
    s_load_dword s10, s[8:9], 0 glc
    s_waitcnt lgkmcnt(0)
    s_memtime s[14:15]
    s_load_dword s11, s[4:5], 0 glc
    s_waitcnt lgkmcnt(0)
    s_memtime s[6:7]
    s_waitcnt lgkmcnt(0)
    s_lshl_b32 s30, s14, 1
    s_sub_u32 s30, s30, s12
    s_sub_u32 s30, s30, s6
    s_cmp_gt_i32 s30, 0
    s_cselect_b32 s30, 1, 0
    s_xor_b32 s30, s30, s33
    s_bfe_u32 s31, s43, 0x10002
    s_xor_b32 s30, s30, s31
    v_xor_b32 v174, s30, v175
    s_lshl_b32 s30, s40, 2
    s_add_u32 s30, s30, s39
    buffer_store_dword v174, v5, s[60:63], s30 offen offset:2048 sc1
Lnw_39:
Lw_43:
    ds_read_b128 v[44:47], v28 offset:32
    s_waitcnt lgkmcnt(0)
    v_max3_u32 v44, v44, v45, v46
    v_max_u32 v44, v44, v47
    v_cmp_eq_u32 vcc, -1, v44
    s_cbranch_vccnz Lre_45
Lok_44:
    ds_read_b64_tr_b16 v[64:65], v33 offset:0
    ds_read_b64_tr_b16 v[66:67], v33 offset:1088
    ds_read_b64_tr_b16 v[68:69], v33 offset:2176
    ds_read_b64_tr_b16 v[70:71], v33 offset:3264
    ds_read_b64_tr_b16 v[72:73], v33 offset:4352
    ds_read_b64_tr_b16 v[74:75], v33 offset:5440
    ds_read_b64_tr_b16 v[76:77], v33 offset:6528
    ds_read_b64_tr_b16 v[78:79], v33 offset:7616
    s_waitcnt lgkmcnt(4)
    ds_read_b64_tr_b16 v[80:81], v33 offset:128
    ds_read_b64_tr_b16 v[82:83], v33 offset:1216
    ds_read_b64_tr_b16 v[84:85], v33 offset:2304
    ds_read_b64_tr_b16 v[86:87], v33 offset:3392
    ds_read_b64_tr_b16 v[88:89], v33 offset:4480
    ds_read_b64_tr_b16 v[90:91], v33 offset:5568
    ds_read_b64_tr_b16 v[92:93], v33 offset:6656
    ds_read_b64_tr_b16 v[94:95], v33 offset:7744
    s_waitcnt lgkmcnt(4)
    s_waitcnt lgkmcnt(0)
    ds_write_b32 v36, v37 offset:48
L_rec:
    s_lshl_b32 s30, s27, 2
    s_add_u32 s30, s30, s28
    s_min_u32 s30, s30, 127
    s_mul_i32 s31, s30, 14
    v_min_u32 v153, 13, v2
    v_add_u32 v153, s31, v153
    v_lshrrev_b32 v154, 2, v153
    v_mul_u32_u24 v154, 3584, v154
    v_and_b32 v155, 3, v153
    v_lshl_add_u32 v154, v155, 7, v154
    s_mul_i32 s31, s26, 448
    s_and_b32 s31, s31, -128
    v_add_u32 v154, s31, v154
    v_min_u32 v153, 1567, v153
    s_mul_i32 s31, s26, 200704
    v_lshl_add_u32 v153, v153, 7, s31
    v_lshl_add_u32 v254, s27, 2, v1
    v_min_u32 v254, (L_code_end-L_att_loop)/128+1, v254
    v_lshlrev_b32 v254, 7, v254
    v_add_u32 v254, L_att_loop-L_code_ref-128, v254
    v_and_b32 v35, 31, v2
    v_lshlrev_b32 v35, 5, v35
    v_lshl_add_u32 v151, v1, 11, v12
    s_mul_i32 s30, s28, 1152
    s_add_u32 s30, s30, 137728
    v_lshl_add_u32 v152, v2, 3, s30
Lw_47:
    ds_read_b32 v44, v28 offset:96
    s_waitcnt lgkmcnt(0)
    v_cmp_eq_u32 vcc, -1, v44
    s_cbranch_vccnz Lre_49
Lok_48:
    global_load_dword v255, v254, s[98:99]
    v_mov_b32 v253, 1605628
    v_cndmask_b32 v253, v37, v253, s[50:51]
    global_load_dword v184, v253, s[16:17]
    global_load_dword v185, v253, s[18:19]
    s_cmp_lg_u32 s28, 0
    s_cbranch_scc1 Lnl_50
    s_cmp_lg_u32 s27, 16
    s_cbranch_scc1 Lnl_50
    buffer_load_dword v186, v9, s[60:63], s39 offen offset:2048 sc1
Lnl_50:
    buffer_load_dwordx2 v[236:237], v35, s[60:63], s39 offen sc1
    buffer_load_dwordx4 v[40:43], v151, s[56:59], s44 offen sc1
    buffer_load_dwordx4 v[44:47], v151, s[56:59], s44 offen offset:1024 sc1
    buffer_load_dwordx2 v[220:221], v181, s[60:63], s45 offen sc1
    buffer_load_dwordx2 v[222:223], v181, s[60:63], s45 offen offset:128 sc1
    s_waitcnt vmcnt(2)
Lq0_46:
    ds_write2_b32 v152, v40, v42 offset0:0 offset1:1
    ds_write2_b32 v152, v44, v46 offset0:144 offset1:145
    v_xor_b32 v149, v237, v175
    v_xor_b32 v148, s43, v236
    v_xor_b32 v41, v41, v175
    v_xor_b32 v43, v43, v175
    v_xor_b32 v45, v45, v175
    v_xor_b32 v47, v47, v175
    v_or3_b32 v41, v41, v43, v45
    v_or3_b32 v41, v41, v47, v149
    v_or_b32 v41, v41, v148
    v_cmp_ne_u32 vcc, 0, v41
    s_cbranch_vccnz Lq0x_51
Lq0d_52:
    ds_write_b32 v28, v34 offset:0
    s_cmp_lg_u32 s28, 0
    s_cbranch_scc1 Lnl_53
    s_cmp_lg_u32 s27, 16
    s_cbranch_scc1 Lnl_53
    v_xor_b32 v186, v186, v175
    v_cmp_eq_u32 vcc, 0, v186
    s_bcnt1_i32_b64 s30, vcc
    v_cmp_eq_u32 vcc, 1, v186
    s_bcnt1_i32_b64 s31, vcc
    s_sub_u32 s30, s31, s30
    s_max_i32 s30, s30, -63
    s_add_u32 s30, s30, 64
    v_mov_b32 v186, s30
    buffer_store_dword v186, v5, s[52:55], s41 offen offset:128 sc1
    s_add_u32 s30, s39, 4096
    buffer_store_dword v175, v5, s[60:63], s30 offen sc1
Lnl_53:
    s_waitcnt lgkmcnt(0)
    s_barrier
    s_waitcnt vmcnt(0)
L_loops_f:
    global_load_dword v184, v154, s[16:17]
    global_load_dword v185, v153, s[18:19]
    s_cmp_ge_u32 s27, 16
    s_cbranch_scc1 L_o_f
L_dry_q1:
    s_call_b64 s[90:91], L_centre
    s_mov_b32 s64, s16
    s_mov_b32 s65, s17
    s_mov_b32 s66, 1605632
    s_mov_b32 s67, 0x20000
    s_mov_b32 s36, s18
    s_mov_b32 s37, s19
    s_mov_b32 s38, 1605632
    s_mov_b32 s39, 0x20000
    v_lshrrev_b32 v13, 1, v2
    v_mul_u32_u24 v13, 3584, v13
    v_and_b32 v14, 1, v2
    v_lshl_add_u32 v13, v14, 4, v13
    s_mul_i32 s32, s26, 14
    s_add_u32 s32, s32, s27
    s_mul_i32 s31, s28, 229376
    v_add_u32 v13, s31, v13
    v_add_u32 v15, 917504, v13
    s_mul_i32 s33, s28, 16896
    s_mul_i32 s30, s32, 14336
    v_lshl_add_u32 v14, v1, 8, v9
    v_cmp_gt_u32 vcc, 896, v14
    s_nop 1
    v_cndmask_b32 v14, v25, v14, vcc
    v_lshlrev_b32 v16, 4, v3
    v_lshl_add_u32 v16, v1, 8, v16
    v_cmp_gt_u32 vcc, 896, v16
    v_mul_u32_u24 v17, 896, v4
    v_add_u32 v16, v16, v17
    v_cndmask_b32 v16, v25, v16, vcc
    v_and_b32 v46, 31, v9
    s_cmp_ge_u32 s27, 14
    s_cbranch_scc1 Lnf_54
    s_lshl_b32 s40, s32, 5
Lw_56:
    ds_read_b128 v[40:43], v28 offset:112
    s_waitcnt lgkmcnt(0)
    v_max3_u32 v40, v40, v41, v42
    v_max_u32 v40, v40, v43
    v_cmp_eq_u32 vcc, -1, v40
    s_cbranch_vccnz Lre_58
Lok_57:
    s_add_u32 m0, s33, 0
    s_add_u32 s31, s40, 0
    buffer_load_dwordx4 v13, s[64:67], s31 offen lds
    s_add_u32 m0, s33, 1024
    s_add_u32 s31, s40, 114688
    buffer_load_dwordx4 v13, s[64:67], s31 offen lds
    s_add_u32 m0, s33, 2048
    s_add_u32 s31, s40, 0
    buffer_load_dwordx4 v15, s[64:67], s31 offen lds
    s_add_u32 m0, s33, 3072
    s_add_u32 s31, s40, 114688
    buffer_load_dwordx4 v15, s[64:67], s31 offen lds
    buffer_load_dword v128, v14, s[36:39], s30 offen offset:0
    buffer_load_dword v129, v14, s[36:39], s30 offen offset:896
    buffer_load_dword v130, v14, s[36:39], s30 offen offset:1792
    buffer_load_dword v131, v14, s[36:39], s30 offen offset:2688
    s_add_u32 s30, s30, 3584
    buffer_load_dword v132, v14, s[36:39], s30 offen offset:0
    buffer_load_dword v133, v14, s[36:39], s30 offen offset:896
    buffer_load_dword v134, v14, s[36:39], s30 offen offset:1792
    buffer_load_dword v135, v14, s[36:39], s30 offen offset:2688
    s_add_u32 s30, s30, 3584
    buffer_load_dword v136, v14, s[36:39], s30 offen offset:0
    buffer_load_dword v137, v14, s[36:39], s30 offen offset:896
    buffer_load_dword v138, v14, s[36:39], s30 offen offset:1792
    buffer_load_dword v139, v14, s[36:39], s30 offen offset:2688
    s_add_u32 s30, s30, 3584
    buffer_load_dword v140, v14, s[36:39], s30 offen offset:0
    buffer_load_dword v141, v14, s[36:39], s30 offen offset:896
    buffer_load_dword v142, v14, s[36:39], s30 offen offset:1792
    buffer_load_dword v143, v14, s[36:39], s30 offen offset:2688
    buffer_load_dword v173, v46, s[52:55], 0 offen offset:128 sc1
    v_lshlrev_b32 v13, 8, v4
    v_lshl_add_u32 v13, v3, 3, v13
    v_add_u32 v13, s33, v13
    v_add_u32 v14, s33, v9
    s_mov_b32 s30, 0x05040100
    s_mov_b32 s31, 0x07060302
    s_waitcnt vmcnt(0)
    ds_read_b64_tr_b16 v[96:97], v13 offset:0
    ds_read_b64_tr_b16 v[98:99], v13 offset:128
    ds_read_b64_tr_b16 v[100:101], v13 offset:1024
    ds_read_b64_tr_b16 v[102:103], v13 offset:1152
    ds_read_b64_tr_b16 v[104:105], v13 offset:2048
    ds_read_b64_tr_b16 v[106:107], v13 offset:2176
    ds_read_b64_tr_b16 v[108:109], v13 offset:3072
    ds_read_b64_tr_b16 v[110:111], v13 offset:3200
    v_perm_b32 v112, v129, v128, s30
    v_perm_b32 v113, v129, v128, s31
    v_perm_b32 v114, v131, v130, s30
    v_perm_b32 v115, v131, v130, s31
    v_perm_b32 v116, v133, v132, s30
    v_perm_b32 v117, v133, v132, s31
    v_perm_b32 v118, v135, v134, s30
    v_perm_b32 v119, v135, v134, s31
    v_perm_b32 v120, v137, v136, s30
    v_perm_b32 v121, v137, v136, s31
    v_perm_b32 v122, v139, v138, s30
    v_perm_b32 v123, v139, v138, s31
    v_perm_b32 v124, v141, v140, s30
    v_perm_b32 v125, v141, v140, s31
    v_perm_b32 v126, v143, v142, s30
    v_perm_b32 v127, v143, v142, s31
    s_waitcnt lgkmcnt(0)
    v_mfma_f32_16x16x32_bf16 v[156:159], v[144:147], v[96:99], 0
    v_mfma_f32_16x16x32_bf16 v[156:159], v[144:147], v[100:103], v[156:159]
    v_mfma_f32_16x16x32_bf16 v[156:159], v[144:147], v[104:107], v[156:159]
    v_mfma_f32_16x16x32_bf16 v[156:159], v[144:147], v[108:111], v[156:159]
    s_nop 7
    ds_write_b32 v30, v156
    ds_read_b128 v[152:155], v33 offset:16
    ds_read_b128 v[148:151], v33
    ds_read_b128 v[44:47], v32
Ls_59:
    s_waitcnt lgkmcnt(2)
    v_pk_add_f32 v[152:153], v[152:153], v[154:155]
    s_waitcnt lgkmcnt(1)
    v_pk_add_f32 v[148:149], v[148:149], v[150:151]
    v_add_f32 v152, v152, v153
    v_add_f32 v148, v148, v149
    s_waitcnt lgkmcnt(0)
    v_pk_add_f32 v[44:45], v[44:45], v[46:47]
    v_add_f32 v44, v44, v45
    v_max3_u32 v45, v44, v148, v152
    v_cmp_eq_u32 vcc, -1, v45
    s_cbranch_vccnz Lre_61
Lok_60:
    v_mov_b32 v39, v44
    v_add_u32 v30, 640, v30
    v_add_u32 v32, 640, v32
    v_add_u32 v33, 640, v33
    v_cmp_eq_u32 vcc, 0, v173
    s_cbranch_vccz Lf_55
    s_branch Lk_62
Lnf_54:
Lw_63:
    ds_read_b128 v[40:43], v28 offset:112
    s_waitcnt lgkmcnt(0)
    v_max3_u32 v40, v40, v41, v42
    v_max_u32 v40, v40, v43
    v_cmp_eq_u32 vcc, -1, v40
    s_cbranch_vccnz Lre_65
Lok_64:
    v_and_b32 v16, 31, v2
    v_lshlrev_b32 v16, 7, v16
    s_and_b32 s30, s27, 1
    s_lshl_b32 s30, s30, 2
    s_add_u32 s30, s30, s28
    s_lshl_b32 s30, s30, 12
    s_add_u32 s30, s30, 65536
Lkp_66:
    buffer_load_dword v40, v16, s[56:59], s30 offen sc1
    buffer_load_dword v41, v31, s[56:59], 0 offen sc1
    s_waitcnt vmcnt(0)
    v_cmp_eq_u32 vcc, -1, v41
    s_cbranch_vccnz Lre_68
Lok_67:
    s_add_u32 s30, s30, 131072
    s_mov_b32 s31, 229376
    buffer_load_dword v40, v16, s[56:59], s30 offen sc1
    buffer_load_dword v40, v6, s[56:59], s31 offen sc1
    s_waitcnt vmcnt(0)
Lk_62:
    v_and_b32 v46, 31, v9
Lf2_69:
    buffer_load_dword v173, v46, s[52:55], 0 offen offset:128 sc1
    s_waitcnt vmcnt(0)
    v_cmp_eq_u32 vcc, 0, v173
    s_cbranch_vccnz Lre_71
Lok_70:
Lf_55:
    v_add_u32_dpp v186, v173, v173 quad_perm:[1,0,3,2] row_mask:0xf bank_mask:0xf
    s_nop 1
    v_add_u32_dpp v186, v186, v186 quad_perm:[2,3,0,1] row_mask:0xf bank_mask:0xf
    s_nop 1
    v_add_u32_dpp v186, v186, v186 row_half_mirror row_mask:0xf bank_mask:0xf
    s_bfe_u32 s31, s43, 0x10002
    v_readfirstlane_b32 s30, v186
    s_cmpk_gt_u32 s30, 512
    s_cselect_b32 s30, 1, 0
    s_xor_b32 s30, s30, s31
    s_lshl_b32 s49, s30, 13
    .p2align 6
L_dry_q2:
L_qloop_f:
    s_cmp_ge_u32 s27, 14
    s_cbranch_scc1 Lskip_72
    s_cmp_lg_u32 s28, 0
    s_cbranch_scc1 Lgo_74
Lgp_73:
    buffer_load_dword v40, v31, s[56:59], s48 offen offset:0 sc1
    s_waitcnt vmcnt(0)
    v_cmp_eq_u32 vcc, -1, v40
    s_cbranch_vccnz Lre_76
Lok_75:
    ds_write_b32 v29, v37 offset:0
Lgo_74:
Lw_77:
    ds_read_b32 v40, v29 offset:0
    s_waitcnt lgkmcnt(0)
    v_cmp_eq_u32 vcc, -1, v40
    s_cbranch_vccnz Lre_79
Lok_78:
    s_add_u32 s44, s48, 102400
    v_mov_b32 v128, 0
    v_mov_b32 v129, 0
    v_mov_b32 v130, 0
    v_mov_b32 v131, 0
Lx_80:
    buffer_load_dwordx4 v[48:51], v20, s[60:63], s49 offen sc1
    buffer_load_dwordx4 v[52:55], v21, s[60:63], s49 offen sc1
    s_nop 3
    v_mov_b32 v156, 0
    v_mov_b32 v157, 0
    v_mov_b32 v158, 0
    v_mov_b32 v159, 0
    s_waitcnt vmcnt(1)
    v_mfma_f32_16x16x32_bf16 v[148:151], v[48:51], v[48:51], 0
    v_max3_u32 v40, v48, v49, v50
    v_mfma_f32_16x16x32_bf16 v[152:155], v[48:51], v[144:147], 0
    s_waitcnt vmcnt(0)
    v_mfma_f32_16x16x32_bf16 v[148:151], v[52:55], v[52:55], v[148:151]
    v_max3_u32 v40, v40, v51, v52
    v_max3_u32 v40, v40, v53, v54
    v_mfma_f32_16x16x32_bf16 v[152:155], v[52:55], v[144:147], v[152:155]
    v_max_u32 v40, v40, v55
    v_cmp_eq_u32 vcc, -1, v40
    v_smfmac_f32_16x16x64_bf16 v[156:159], v[48:51], v[96:103], v183
    v_smfmac_f32_16x16x64_bf16 v[156:159], v[52:55], v[104:111], v183
    s_nop 0
    v_pk_add_f32 v[40:41], v[148:149], v[150:151]
    v_add_f32 v40, v40, v41
    s_nop 0
    v_pk_add_f32 v[42:43], v[152:153], v[154:155]
    s_cbranch_vccnz Lre_82
Lok_81:
    v_add_f32_dpp v40, v40, v40 quad_perm:[1,0,3,2] row_mask:0xf bank_mask:0xf
    v_add_f32 v42, v42, v43
    s_nop 0
    v_add_f32_dpp v40, v40, v40 quad_perm:[2,3,0,1] row_mask:0xf bank_mask:0xf
    v_pk_add_f32 v[156:157], v[156:157], v[158:159]
    s_nop 0
    v_add_f32_dpp v40, v40, v40 row_half_mirror row_mask:0xf bank_mask:0xf
    v_add_f32 v44, v156, v157
    s_nop 0
    v_mov_b32_dpp v40, v40 row_ror:8 row_mask:0xc bank_mask:0xf
    v_cndmask_b32 v40, v42, v40, s[88:89]
    s_nop 0
    s_nop 0
    v_permlane32_swap_b32 v44, v40
    v_add_f32 v45, v44, v40
    v_add_f32 v44, v44, v40
    s_nop 1
    v_permlane16_swap_b32 v44, v45
    v_add_f32 v44, v44, v45
    ds_write_b32 v30, v44
    ds_read_b128 v[152:155], v33 offset:16
    ds_read_b128 v[148:151], v33
    ds_read_b128 v[44:47], v32
Ls_83:
    s_waitcnt lgkmcnt(2)
    v_pk_add_f32 v[152:153], v[152:153], v[154:155]
    s_waitcnt lgkmcnt(1)
    v_pk_add_f32 v[148:149], v[148:149], v[150:151]
    v_add_f32 v152, v152, v153
    v_add_f32 v148, v148, v149
    v_mul_f32 v42, s47, v152
    v_fma_f32 v43, v148, s47, v187
    s_waitcnt lgkmcnt(0)
    v_pk_add_f32 v[44:45], v[44:45], v[46:47]
    v_fma_f32 v43, -v42, v42, v43
    v_add_f32 v44, v44, v45
    v_max_f32 v43, v187, v43
    v_max3_u32 v45, v44, v148, v152
    v_cmp_eq_u32 vcc, -1, v45
    v_rsq_f32 v43, v43
    v_fma_f32 v41, -v42, v39, v44
    v_mul_f32 v41, v41, v43
    v_mul_f32 v42, 0xbfb8aa3b, v41
    v_exp_f32 v42, v42
    s_cbranch_vccnz Lre_85
Lok_84:
    v_add_f32 v42, 1.0, v42
    v_rcp_f32 v42, v42
    s_nop 0
    v_mul_f32 v41, v41, v42
    s_nop 1
    v_mov_b32_dpp v42, v41 quad_perm:[1,0,3,2] row_mask:0xf bank_mask:0xf
    v_cvt_pk_bf16_f32 v41, v41, v42
    s_nop 1
    v_dot2c_f32_bf16_dpp v128, v41, v112 row_newbcast:0 row_mask:0xf bank_mask:0xf
    v_dot2c_f32_bf16_dpp v129, v41, v113 row_newbcast:0 row_mask:0xf bank_mask:0xf
    v_dot2c_f32_bf16_dpp v130, v41, v114 row_newbcast:2 row_mask:0xf bank_mask:0xf
    v_dot2c_f32_bf16_dpp v131, v41, v115 row_newbcast:2 row_mask:0xf bank_mask:0xf
    v_dot2c_f32_bf16_dpp v128, v41, v116 row_newbcast:4 row_mask:0xf bank_mask:0xf
    v_dot2c_f32_bf16_dpp v129, v41, v117 row_newbcast:4 row_mask:0xf bank_mask:0xf
    v_dot2c_f32_bf16_dpp v130, v41, v118 row_newbcast:6 row_mask:0xf bank_mask:0xf
    v_dot2c_f32_bf16_dpp v131, v41, v119 row_newbcast:6 row_mask:0xf bank_mask:0xf
    v_dot2c_f32_bf16_dpp v128, v41, v120 row_newbcast:8 row_mask:0xf bank_mask:0xf
    v_dot2c_f32_bf16_dpp v129, v41, v121 row_newbcast:8 row_mask:0xf bank_mask:0xf
    v_dot2c_f32_bf16_dpp v130, v41, v122 row_newbcast:10 row_mask:0xf bank_mask:0xf
    v_dot2c_f32_bf16_dpp v131, v41, v123 row_newbcast:10 row_mask:0xf bank_mask:0xf
    v_dot2c_f32_bf16_dpp v128, v41, v124 row_newbcast:12 row_mask:0xf bank_mask:0xf
    v_dot2c_f32_bf16_dpp v129, v41, v125 row_newbcast:12 row_mask:0xf bank_mask:0xf
    v_dot2c_f32_bf16_dpp v130, v41, v126 row_newbcast:14 row_mask:0xf bank_mask:0xf
    v_dot2c_f32_bf16_dpp v131, v41, v127 row_newbcast:14 row_mask:0xf bank_mask:0xf
    s_nop 2
    v_pk_add_f32 v[128:129], v[128:129], v[130:131]
    buffer_store_dwordx2 v[128:129], v18, s[56:59], s44 offen
    v_add_u32 v30, 640, v30
    v_add_u32 v32, 640, v32
    v_add_u32 v33, 640, v33
Lskip_72:
L_dry_q3:
    s_cmp_lg_u32 s46, 0
    s_cbranch_scc1 Lqe_86
    s_add_u32 s49, s49, 16384
    s_cmp_lg_u32 s28, 0
    s_cbranch_scc1 Lgo_88
Lgp_87:
    buffer_load_dword v40, v31, s[56:59], s48 offen offset:1024 sc1
    s_waitcnt vmcnt(0)
    v_cmp_eq_u32 vcc, -1, v40
    s_cbranch_vccnz Lre_90
Lok_89:
    ds_write_b32 v29, v37 offset:4
Lgo_88:
Lw_91:
    ds_read_b32 v40, v29 offset:4
    s_waitcnt lgkmcnt(0)
    v_cmp_eq_u32 vcc, -1, v40
    s_cbranch_vccnz Lre_93
Lok_92:
    s_mov_b32 s44, 229376
Lqf_94:
    buffer_load_dwordx4 v[56:59], v22, s[60:63], s49 offen sc1
    buffer_load_dwordx4 v[60:63], v23, s[60:63], s49 offen sc1
    s_nop 3
    v_mov_b32 v156, 0
    v_mov_b32 v157, 0
    v_mov_b32 v158, 0
    v_mov_b32 v159, 0
    v_mov_b32 v160, 0
    v_mov_b32 v161, 0
    v_mov_b32 v162, 0
    v_mov_b32 v163, 0
    s_waitcnt vmcnt(1)
    v_smfmac_f32_16x16x64_bf16 v[156:159], v[56:59], v[64:71], v183
    v_max3_u32 v40, v56, v57, v58
    v_smfmac_f32_16x16x64_bf16 v[160:163], v[56:59], v[80:87], v183
    s_waitcnt vmcnt(0)
    v_smfmac_f32_16x16x64_bf16 v[156:159], v[60:63], v[72:79], v183
    v_max3_u32 v40, v40, v59, v60
    v_max3_u32 v40, v40, v61, v62
    v_smfmac_f32_16x16x64_bf16 v[160:163], v[60:63], v[88:95], v183
    v_max_u32 v40, v40, v63
    v_cmp_eq_u32 vcc, -1, v40
    s_nop 2
    v_pk_add_f32 v[156:157], v[156:157], v[158:159]
    s_nop 1
    v_pk_add_f32 v[160:161], v[160:161], v[162:163]
    v_add_f32 v156, v156, v157
    v_add_f32 v160, v160, v161
    s_cbranch_vccnz Lre_96
Lok_95:
    s_nop 0
    v_permlane32_swap_b32 v156, v160
    v_add_f32 v44, v156, v160
    v_add_f32 v46, v156, v160
    s_nop 1
    v_permlane16_swap_b32 v44, v46
    v_add_f32 v41, v44, v46
    s_nop 1
    v_mov_b32_dpp v42, v41 quad_perm:[1,0,3,2] row_mask:0xf bank_mask:0xf
    v_cvt_pk_bf16_f32 v42, v41, v42
    buffer_store_dword v42, v24, s[56:59], s44 offen
Lx_97:
    buffer_load_dwordx4 v[48:51], v20, s[60:63], s49 offen sc1
    buffer_load_dwordx4 v[52:55], v21, s[60:63], s49 offen sc1
    s_waitcnt vmcnt(1)
    v_mfma_f32_16x16x32_bf16 v[148:151], v[48:51], v[48:51], 0
    v_max3_u32 v40, v48, v49, v50
    v_mfma_f32_16x16x32_bf16 v[152:155], v[48:51], v[144:147], 0
    s_waitcnt vmcnt(0)
    v_mfma_f32_16x16x32_bf16 v[148:151], v[52:55], v[52:55], v[148:151]
    v_max3_u32 v40, v40, v51, v52
    v_max3_u32 v40, v40, v53, v54
    v_mfma_f32_16x16x32_bf16 v[152:155], v[52:55], v[144:147], v[152:155]
    v_max_u32 v40, v40, v55
    v_cmp_eq_u32 vcc, -1, v40
    s_nop 3
    v_pk_add_f32 v[40:41], v[148:149], v[150:151]
    v_add_f32 v40, v40, v41
    v_pk_add_f32 v[42:43], v[152:153], v[154:155]
    s_cbranch_vccnz Lre_99
Lok_98:
    s_mov_b32 s30, 229376
    buffer_load_dwordx4 v[44:47], v6, s[56:59], s30 offen sc1
    v_add_f32_dpp v40, v40, v40 quad_perm:[1,0,3,2] row_mask:0xf bank_mask:0xf
    v_add_f32 v42, v42, v43
    s_nop 0
    v_add_f32_dpp v40, v40, v40 quad_perm:[2,3,0,1] row_mask:0xf bank_mask:0xf
    s_nop 1
    v_add_f32_dpp v40, v40, v40 row_half_mirror row_mask:0xf bank_mask:0xf
    s_nop 1
    v_mov_b32_dpp v40, v40 row_ror:8 row_mask:0xc bank_mask:0xf
    v_cndmask_b32 v41, v42, v40, s[88:89]
    v_cndmask_b32 v40, v42, v40, s[88:89]
    s_nop 1
    v_permlane32_swap_b32 v40, v41
    v_add_f32 v42, v40, v41
    v_add_f32 v40, v40, v41
    s_nop 1
    v_permlane16_swap_b32 v40, v42
    v_add_f32 v40, v40, v42
    ds_write_b32 v240, v40 offset:32
Lqp_100:
    s_waitcnt vmcnt(0)
    ds_write_b128 v26, v[44:47]
    v_max3_u32 v40, v44, v45, v46
    v_max_u32 v40, v40, v47
    v_cmp_eq_u32 vcc, -1, v40
    s_cbranch_vccnz Lre_102
Lok_101:
    s_waitcnt lgkmcnt(0)
    s_barrier
    s_mov_b32 s46, 1
    s_mov_b32 s48, 131072
    s_add_u32 s49, s49, 16384
    v_add_u32 v29, 8, v29
    s_branch L_qloop_f
Lqe_86:
    s_endpgm
Lre_42:
    s_sub_u32 s29, s29, 1
    s_cbranch_scc0 Lw_40
    s_mov_b32 s29, 0
    s_branch Lok_41
Lre_45:
    s_sub_u32 s29, s29, 1
    s_cbranch_scc0 Lw_43
    s_mov_b32 s29, 0
    s_branch Lok_44
Lre_49:
    s_sub_u32 s29, s29, 1
    s_cbranch_scc0 Lw_47
    s_mov_b32 s29, 0
    s_branch Lok_48
Lq0x_51:
    v_cmp_ne_u32 vcc, 0, v149
    s_cbranch_vccnz Lq0x_51b
    v_cmp_ne_u32 vcc, 0, v148
    s_cbranch_vccnz L_slow_entry
Lq0x_51b:
    buffer_load_dwordx2 v[236:237], v35, s[60:63], s39 offen sc1
    buffer_load_dwordx4 v[40:43], v151, s[56:59], s44 offen sc1
    buffer_load_dwordx4 v[44:47], v151, s[56:59], s44 offen offset:1024 sc1
    s_waitcnt vmcnt(0)
    s_sub_u32 s29, s29, 1
    s_cbranch_scc0 Lq0_46
    s_mov_b32 s29, 0
    s_branch Lq0d_52
Lre_58:
    s_sub_u32 s29, s29, 1
    s_cbranch_scc0 Lw_56
    s_mov_b32 s29, 0
    s_branch Lok_57
Lre_61:
    ds_read_b128 v[152:155], v33 offset:16
    ds_read_b128 v[148:151], v33
    ds_read_b128 v[44:47], v32
    s_sub_u32 s29, s29, 1
    s_cbranch_scc0 Ls_59
    s_mov_b32 s29, 0
    s_waitcnt lgkmcnt(0)
    s_branch Lok_60
Lre_65:
    s_sub_u32 s29, s29, 1
    s_cbranch_scc0 Lw_63
    s_mov_b32 s29, 0
    s_branch Lok_64
Lre_68:
    s_sub_u32 s29, s29, 1
    s_cbranch_scc0 Lkp_66
    s_mov_b32 s29, 0
    s_branch Lok_67
Lre_71:
    s_sub_u32 s29, s29, 1
    s_cbranch_scc0 Lf2_69
    s_mov_b32 s29, 0
    s_branch Lok_70
Lre_76:
    s_sub_u32 s29, s29, 1
    s_cbranch_scc0 Lgp_73
    s_mov_b32 s29, 0
    s_branch Lok_75
Lre_79:
    s_sub_u32 s29, s29, 1
    s_cbranch_scc0 Lw_77
    s_mov_b32 s29, 0
    s_branch Lok_78
Lre_82:
    s_sub_u32 s29, s29, 1
    s_cbranch_scc0 Lx_80
    s_mov_b32 s29, 0
    s_branch Lok_81
Lre_85:
    ds_read_b128 v[152:155], v33 offset:16
    ds_read_b128 v[148:151], v33
    ds_read_b128 v[44:47], v32
    s_sub_u32 s29, s29, 1
    s_cbranch_scc0 Ls_83
    s_mov_b32 s29, 0
    s_waitcnt lgkmcnt(0)
    s_branch Lok_84
Lre_90:
    s_sub_u32 s29, s29, 1
    s_cbranch_scc0 Lgp_87
    s_mov_b32 s29, 0
    s_branch Lok_89
Lre_93:
    s_sub_u32 s29, s29, 1
    s_cbranch_scc0 Lw_91
    s_mov_b32 s29, 0
    s_branch Lok_92
Lre_96:
    s_sub_u32 s29, s29, 1
    s_cbranch_scc0 Lqf_94
    s_mov_b32 s29, 0
    s_branch Lok_95
Lre_99:
    s_sub_u32 s29, s29, 1
    s_cbranch_scc0 Lx_97
    s_mov_b32 s29, 0
    s_branch Lok_98
Lre_102:
    buffer_load_dwordx4 v[44:47], v6, s[56:59], s30 offen sc1
    s_sub_u32 s29, s29, 1
    s_cbranch_scc0 Lqp_100
    s_mov_b32 s29, 0
    s_waitcnt vmcnt(0)
    s_branch Lok_101
L_o_f:
L_dry_o1:
    buffer_load_dword v180, v15, s[56:59], 0 offen sc1
Lw_103:
    ds_read_b128 v[44:47], v28 offset:64
    s_waitcnt lgkmcnt(0)
    v_max3_u32 v44, v44, v45, v46
    v_max_u32 v44, v44, v47
    v_cmp_eq_u32 vcc, -1, v44
    s_cbranch_vccnz Lre_105
Lok_104:
    v_and_b32 v182, 31, v9
    .p2align 6
L_oloop_f:
    v_mov_b32 v123, 0
    v_mov_b32 v228, -1
    v_mov_b32 v229, -1
    v_mov_b32 v230, -1
    v_mov_b32 v231, -1
    v_mov_b32 v124, -1
    v_mov_b32 v125, -1
    v_mov_b32 v126, -1
    v_mov_b32 v127, -1
Lw_106:
    ds_read_b128 v[44:47], v32 offset:0
    s_waitcnt lgkmcnt(0)
    v_max3_u32 v44, v44, v45, v46
    v_max_u32 v44, v44, v47
    v_cmp_eq_u32 vcc, -1, v44
    s_cbranch_vccnz Lre_108
Lok_107:
Lm_109:
    buffer_load_dwordx4 v[40:43], v7, s[56:59], s48 offen sc1
    buffer_load_dword v180, v15, s[56:59], s48 offen sc1
    s_waitcnt vmcnt(1)
    v_max3_u32 v44, v40, v41, v42
    v_max_u32 v44, v44, v43
    v_cmp_eq_u32 vcc, -1, v44
    v_max3_f32 v40, v40, v41, v42
    v_max_f32 v40, v40, v43
    s_cbranch_vccnz Lre_111
Lok_110:
    buffer_load_dwordx4 v[188:191], v15, s[56:59], s48 offen sc1
    v_mov_b32 v41, v40
    v_mov_b32 v42, v40
    v_max_f32_dpp v40, v40, v40 row_ror:8 row_mask:0xf bank_mask:0xf
    s_nop 0
    v_permlane16_swap_b32 v41, v42
    v_max_f32_dpp v40, v40, v40 row_ror:4 row_mask:0xf bank_mask:0xf
    s_nop 0
    v_mov_b32_dpp v41, v41 row_ror:8 row_mask:0xf bank_mask:0xc
    v_max_f32_dpp v40, v40, v40 row_ror:2 row_mask:0xf bank_mask:0xf
    s_nop 1
    v_max_f32_dpp v40, v40, v40 row_ror:1 row_mask:0xf bank_mask:0xf
    v_mov_b32 v45, v40
    s_nop 1
    v_permlane16_swap_b32 v40, v45
    v_max_f32 v40, v40, v45
    v_sub_f32 v41, v41, v40
    v_exp_f32 v41, v41
    s_add_u32 s31, s48, 94208
    s_add_u32 s30, s48, 65536
Lo_112:
    s_waitcnt vmcnt(0)
    v_max3_u32 v44, v188, v189, v190
    v_max_u32 v44, v44, v191
    v_cmp_eq_u32 vcc, -1, v44
    v_mul_f32 v132, v41, v188
    v_mul_f32 v133, v41, v189
    v_mul_f32 v134, v41, v190
    v_mul_f32 v135, v41, v191
    v_add_f32_dpp v132, v132, v132 quad_perm:[1,0,3,2] row_mask:0xf bank_mask:0xf
    v_add_f32_dpp v133, v133, v133 quad_perm:[1,0,3,2] row_mask:0xf bank_mask:0xf
    v_add_f32_dpp v134, v134, v134 quad_perm:[1,0,3,2] row_mask:0xf bank_mask:0xf
    v_add_f32_dpp v135, v135, v135 quad_perm:[1,0,3,2] row_mask:0xf bank_mask:0xf
    s_cbranch_vccnz Lre_115
Lok_114:
    v_add_f32_dpp v132, v132, v132 quad_perm:[2,3,0,1] row_mask:0xf bank_mask:0xf
    v_add_f32_dpp v133, v133, v133 quad_perm:[2,3,0,1] row_mask:0xf bank_mask:0xf
    v_add_f32_dpp v134, v134, v134 quad_perm:[2,3,0,1] row_mask:0xf bank_mask:0xf
    v_add_f32_dpp v135, v135, v135 quad_perm:[2,3,0,1] row_mask:0xf bank_mask:0xf
    v_add_f32_dpp v132, v132, v132 row_half_mirror row_mask:0xf bank_mask:0xf
    v_add_f32_dpp v133, v133, v133 row_half_mirror row_mask:0xf bank_mask:0xf
    v_add_f32_dpp v134, v134, v134 row_half_mirror row_mask:0xf bank_mask:0xf
    v_add_f32_dpp v135, v135, v135 row_half_mirror row_mask:0xf bank_mask:0xf
    v_cvt_pk_bf16_f32 v46, v132, v133
    v_cvt_pk_bf16_f32 v47, v134, v135
    ds_write_b64 v10, v[46:47]
    s_cmp_lg_u32 s28, s3
    ds_read_b64 v[44:45], v11
    s_cbranch_scc1 Lnl_117
    buffer_load_dword v123, v182, s[52:55], 0 offen offset:128 sc1
    buffer_load_dwordx4 v[228:231], v12, s[56:59], s31 offen sc1
    buffer_load_dwordx4 v[124:127], v12, s[56:59], s31 offen offset:1024 sc1
Lnl_117:
Lox_116:
    s_waitcnt lgkmcnt(0)
    v_max_u32 v46, v44, v45
    v_cmp_eq_u32 vcc, -1, v46
    v_mfma_f32_4x4x4_16b_bf16 v[128:131], v[44:45], v[64:65], 0 cbsz:4 abid:0
    v_mfma_f32_4x4x4_16b_bf16 v[136:139], v[44:45], v[80:81], 0 cbsz:4 abid:0
    v_mfma_f32_4x4x4_16b_bf16 v[132:135], v[44:45], v[66:67], 0 cbsz:4 abid:1
    v_mfma_f32_4x4x4_16b_bf16 v[140:143], v[44:45], v[82:83], 0 cbsz:4 abid:1
    s_cbranch_vccnz Lre_119
Lok_118:
    v_mfma_f32_4x4x4_16b_bf16 v[128:131], v[44:45], v[68:69], v[128:131] cbsz:4 abid:2
    v_mfma_f32_4x4x4_16b_bf16 v[136:139], v[44:45], v[84:85], v[136:139] cbsz:4 abid:2
    v_mfma_f32_4x4x4_16b_bf16 v[132:135], v[44:45], v[70:71], v[132:135] cbsz:4 abid:3
    v_mfma_f32_4x4x4_16b_bf16 v[140:143], v[44:45], v[86:87], v[140:143] cbsz:4 abid:3
    v_mfma_f32_4x4x4_16b_bf16 v[128:131], v[44:45], v[72:73], v[128:131] cbsz:4 abid:4
    v_mfma_f32_4x4x4_16b_bf16 v[136:139], v[44:45], v[88:89], v[136:139] cbsz:4 abid:4
    v_mfma_f32_4x4x4_16b_bf16 v[132:135], v[44:45], v[74:75], v[132:135] cbsz:4 abid:5
    v_mfma_f32_4x4x4_16b_bf16 v[140:143], v[44:45], v[90:91], v[140:143] cbsz:4 abid:5
    v_mfma_f32_4x4x4_16b_bf16 v[128:131], v[44:45], v[76:77], v[128:131] cbsz:4 abid:6
    v_mfma_f32_4x4x4_16b_bf16 v[136:139], v[44:45], v[92:93], v[136:139] cbsz:4 abid:6
    v_mfma_f32_4x4x4_16b_bf16 v[132:135], v[44:45], v[78:79], v[132:135] cbsz:4 abid:7
    v_mfma_f32_4x4x4_16b_bf16 v[140:143], v[44:45], v[94:95], v[140:143] cbsz:4 abid:7
    s_nop 1
    v_pk_add_f32 v[128:129], v[128:129], v[130:131]
    v_pk_add_f32 v[136:137], v[136:137], v[138:139]
    v_pk_add_f32 v[132:133], v[132:133], v[134:135]
    v_pk_add_f32 v[140:141], v[140:141], v[142:143]
    v_pk_add_f32 v[128:129], v[128:129], v[132:133]
    v_pk_add_f32 v[136:137], v[136:137], v[140:141]
    v_add_f32 v128, v128, v129
    v_add_f32 v136, v136, v137
    buffer_store_dword v128, v16, s[56:59], s30 offen
    buffer_store_dword v136, v17, s[56:59], s30 offen
    s_cmp_lg_u32 s28, s3
    s_cbranch_scc1 Lnr_120
L_dry_o2:
    s_waitcnt vmcnt(2)
Ll_122:
    v_add_u32 v42, -1, v123
    v_max3_u32 v41, v228, v124, v125
    v_max3_u32 v41, v41, v126, v127
    v_max3_u32 v42, v42, v229, v230
    v_max3_u32 v41, v41, v42, v231
    v_max3_f32 v122, v228, v229, v230
    v_max_f32 v122, v122, v231
    v_cmp_eq_u32 vcc, -1, v41
    s_cbranch_vccz Lok_123
    buffer_load_dword v123, v182, s[52:55], 0 offen offset:128 sc1
    buffer_load_dwordx4 v[228:231], v12, s[56:59], s31 offen sc1
    buffer_load_dwordx4 v[124:127], v12, s[56:59], s31 offen offset:1024 sc1
    s_waitcnt vmcnt(0)
    s_sub_u32 s29, s29, 1
    s_cbranch_scc0 Ll_122
    s_mov_b32 s29, 0
Lok_123:
    v_max_f32_dpp v41, v122, v122 row_ror:8 row_mask:0xf bank_mask:0xf
    v_add_f32 v124, v124, v125
    v_add_f32 v126, v126, v127
    v_max_f32_dpp v41, v41, v41 row_ror:4 row_mask:0xf bank_mask:0xf
    v_add_f32 v124, v124, v126
    s_nop 0
    v_max_f32_dpp v41, v41, v41 row_ror:2 row_mask:0xf bank_mask:0xf
    s_nop 1
    v_max_f32_dpp v41, v41, v41 row_ror:1 row_mask:0xf bank_mask:0xf
    v_mov_b32 v45, v41
    s_nop 1
    v_permlane16_swap_b32 v41, v45
    v_max_f32 v41, v41, v45
    v_sub_f32 v40, v122, v41
    v_exp_f32 v40, v40
    s_nop 0
    v_mul_f32 v44, v124, v40
    s_nop 1
    v_add_f32_dpp v44, v44, v44 row_ror:8 row_mask:0xf bank_mask:0xf
    s_nop 1
    v_add_f32_dpp v44, v44, v44 row_ror:4 row_mask:0xf bank_mask:0xf
    s_nop 1
    v_add_f32_dpp v44, v44, v44 row_ror:2 row_mask:0xf bank_mask:0xf
    s_nop 1
    v_add_f32_dpp v44, v44, v44 row_ror:1 row_mask:0xf bank_mask:0xf
    v_mov_b32 v45, v44
    s_nop 1
    v_permlane16_swap_b32 v44, v45
    v_add_f32 v44, v44, v45
    v_rcp_f32 v120, v44
    v_rcp_f32 v121, v44
    s_nop 1
    v_permlane32_swap_b32 v120, v121
Lr_124:
    buffer_load_dwordx4 v[196:199], v13, s[56:59], s30 offen offset:0 sc1
    buffer_load_dwordx4 v[200:203], v13, s[56:59], s30 offen offset:1024 sc1
    buffer_load_dwordx4 v[204:207], v13, s[56:59], s30 offen offset:2048 sc1
    buffer_load_dwordx4 v[208:211], v13, s[56:59], s30 offen offset:3072 sc1
    s_waitcnt vmcnt(2)
    v_pk_add_f32 v[96:97], v[196:197], v[200:201]
    v_pk_add_f32 v[98:99], v[198:199], v[202:203]
    v_max3_u32 v44, v96, v97, v98
    v_mul_f32 v100, v96, v120
    v_mul_f32 v101, v97, v120
    v_mul_f32 v102, v98, v120
    v_mul_f32 v103, v99, v120
    s_waitcnt vmcnt(0)
    v_pk_add_f32 v[104:105], v[204:205], v[208:209]
    v_pk_add_f32 v[106:107], v[206:207], v[210:211]
    v_max3_u32 v44, v44, v99, v104
    v_max3_u32 v45, v105, v106, v107
    v_max_u32 v44, v44, v45
    v_cmp_eq_u32 vcc, -1, v44
    v_fmac_f32 v100, v104, v121
    v_fmac_f32 v101, v105, v121
    v_fmac_f32 v102, v106, v121
    v_fmac_f32 v103, v107, v121
    s_nop 0
    v_permlane32_swap_b32 v100, v102
    v_permlane32_swap_b32 v101, v103
    v_pk_add_f32 v[100:101], v[100:101], v[102:103]
    v_pk_add_f32 v[112:113], v[100:101], v[176:177]
    v_pk_add_f32 v[114:115], v[100:101], v[176:177]
    s_cbranch_vccnz Lre_126
Lok_125:
    s_nop 0
    v_permlane16_swap_b32 v112, v114
    v_permlane16_swap_b32 v113, v115
    v_pk_add_f32 v[112:113], v[112:113], v[114:115]
    v_cvt_pk_bf16_f32 v44, v112, v113
    buffer_store_dword v37, v30, s[56:59], s48 offen offset:0
    buffer_store_dword v44, v19, s[60:63], s49 offen sc1

    s_add_u32 s35, s49, s40
    s_add_u32 s49, s49, 16384
    v_and_b32 v181, 31, v2
    s_lshl_b32 s31, s34, 12
    v_lshl_add_u32 v181, v181, 7, s31
    s_add_u32 s30, s48, 102400
    buffer_load_dword v180, v181, s[56:59], s30 offen sc1
    s_cmp_lg_u32 s46, 0
    s_cbranch_scc1 Lv_127
    v_add_u32_dpp v186, v123, v123 quad_perm:[1,0,3,2] row_mask:0xf bank_mask:0xf
    s_nop 1
    v_add_u32_dpp v186, v186, v186 quad_perm:[2,3,0,1] row_mask:0xf bank_mask:0xf
    s_nop 1
    v_add_u32_dpp v186, v186, v186 row_half_mirror row_mask:0xf bank_mask:0xf
    s_bfe_u32 s31, s43, 0x10002
    v_readfirstlane_b32 s30, v186
    s_cmpk_gt_u32 s30, 512
    s_cselect_b32 s30, 1, 0
    s_xor_b32 s30, s30, s31
    s_lshl_b32 s40, s30, 13
    s_mov_b32 s35, s40
Lv_127:
    v_cndmask_b32 v178, 0, v112, s[92:93]
    v_cndmask_b32 v179, 0, v113, s[92:93]
    s_waitcnt vmcnt(0)
Lrs_128:
    buffer_load_dword v116, v22, s[60:63], s35 offen sc1
    buffer_load_dword v117, v23, s[60:63], s35 offen offset:256 sc1
    buffer_load_dword v118, v23, s[60:63], s35 offen offset:512 sc1
    buffer_load_dword v119, v23, s[60:63], s35 offen offset:768 sc1
    s_waitcnt vmcnt(0)
    v_max3_u32 v44, v116, v117, v118
    v_max_u32 v44, v44, v119
    v_cmp_eq_u32 vcc, -1, v44
    v_lshlrev_b32 v100, 16, v116
    v_and_b32 v101, 0xffff0000, v116
    v_lshlrev_b32 v102, 16, v117
    v_and_b32 v103, 0xffff0000, v117
    v_lshlrev_b32 v104, 16, v118
    v_and_b32 v105, 0xffff0000, v118
    v_lshlrev_b32 v106, 16, v119
    v_and_b32 v107, 0xffff0000, v119
    s_cbranch_vccnz Lre_130
Lok_129:
    v_pk_add_f32 v[100:101], v[100:101], v[102:103]
    v_pk_add_f32 v[104:105], v[104:105], v[106:107]
    v_pk_add_f32 v[100:101], v[100:101], v[178:179]
    v_pk_add_f32 v[176:177], v[100:101], v[104:105]
L_dry_o3:
    s_add_u32 s30, s48, 102400
Lr_131:
    buffer_load_dwordx4 v[196:199], v13, s[56:59], s30 offen offset:0 sc1
    buffer_load_dwordx4 v[200:203], v13, s[56:59], s30 offen offset:1024 sc1
    buffer_load_dwordx4 v[204:207], v13, s[56:59], s30 offen offset:2048 sc1
    buffer_load_dwordx4 v[208:211], v14, s[56:59], s30 offen offset:3072 sc1
    s_waitcnt vmcnt(2)
    v_pk_add_f32 v[96:97], v[196:197], v[200:201]
    v_pk_add_f32 v[98:99], v[198:199], v[202:203]
    s_waitcnt vmcnt(0)
    v_pk_add_f32 v[104:105], v[204:205], v[208:209]
    v_pk_add_f32 v[106:107], v[206:207], v[210:211]
    v_pk_add_f32 v[100:101], v[104:105], v[96:97]
    v_pk_add_f32 v[102:103], v[106:107], v[98:99]
    v_max3_u32 v44, v100, v101, v102
    v_max_u32 v44, v44, v103
    v_cmp_eq_u32 vcc, -1, v44
    v_permlane32_swap_b32 v100, v102
    v_permlane32_swap_b32 v101, v103
    v_pk_add_f32 v[100:101], v[100:101], v[102:103]
    v_pk_add_f32 v[112:113], v[100:101], v[176:177]
    v_pk_add_f32 v[114:115], v[100:101], v[176:177]
    s_cbranch_vccnz Lre_133
Lok_132:
    s_nop 0
    v_permlane16_swap_b32 v112, v114
    v_permlane16_swap_b32 v113, v115
    v_pk_add_f32 v[112:113], v[112:113], v[114:115]
    v_cvt_pk_bf16_f32 v44, v112, v113
    buffer_store_dword v37, v30, s[56:59], s48 offen offset:1024
    buffer_store_dword v44, v19, s[60:63], s49 offen sc1

    s_add_u32 s35, s49, s40
    s_add_u32 s49, s49, 16384
    v_cndmask_b32 v178, 0, v112, s[92:93]
    v_cndmask_b32 v179, 0, v113, s[92:93]
    s_waitcnt vmcnt(0)
Lrs_134:
    buffer_load_dword v116, v22, s[60:63], s35 offen sc1
    buffer_load_dword v117, v23, s[60:63], s35 offen offset:256 sc1
    buffer_load_dword v118, v23, s[60:63], s35 offen offset:512 sc1
    buffer_load_dword v119, v23, s[60:63], s35 offen offset:768 sc1
    s_waitcnt vmcnt(0)
    v_max3_u32 v44, v116, v117, v118
    v_max_u32 v44, v44, v119
    v_cmp_eq_u32 vcc, -1, v44
    v_lshlrev_b32 v100, 16, v116
    v_and_b32 v101, 0xffff0000, v116
    v_lshlrev_b32 v102, 16, v117
    v_and_b32 v103, 0xffff0000, v117
    v_lshlrev_b32 v104, 16, v118
    v_and_b32 v105, 0xffff0000, v118
    v_lshlrev_b32 v106, 16, v119
    v_and_b32 v107, 0xffff0000, v119
    s_cbranch_vccnz Lre_136
Lok_135:
    v_pk_add_f32 v[100:101], v[100:101], v[102:103]
    v_pk_add_f32 v[104:105], v[104:105], v[106:107]
    v_pk_add_f32 v[100:101], v[100:101], v[178:179]
    v_pk_add_f32 v[176:177], v[100:101], v[104:105]
    s_cmp_lg_u32 s46, 0
    s_cbranch_scc1 Lfin_121
Lnr_120:
    s_cmp_lg_u32 s46, 0
    s_cbranch_scc1 L_end
    s_cmp_lt_u32 s34, 8
    s_cbranch_scc1 Lt_137
    s_mov_b32 s30, 131072
    buffer_load_dword v180, v15, s[56:59], s30 offen sc1
    s_mov_b32 s30, 98304
    buffer_load_dword v180, v15, s[56:59], s30 offen sc1
Lt_137:
    s_cmp_lg_u32 s28, 0
    s_cbranch_scc1 Lgo_138
Lgp_140:
    buffer_load_dword v40, v31, s[56:59], s48 offen offset:1024 sc1
    s_waitcnt vmcnt(0)
    v_cmp_eq_u32 vcc, -1, v40
    s_cbranch_vccnz Lre_142
Lok_141:
    ds_write_b32 v29, v37 offset:4
    s_branch Lgj_139
Lgo_138:
Lw_143:
    ds_read_b32 v40, v29 offset:4
    s_waitcnt lgkmcnt(0)
    v_cmp_eq_u32 vcc, -1, v40
    s_cbranch_vccnz Lre_145
Lok_144:
Lgj_139:
    v_and_b32 v46, 31, v9
Lf2_146:
    buffer_load_dword v173, v46, s[52:55], 0 offen offset:128 sc1
    s_waitcnt vmcnt(0)
    v_cmp_eq_u32 vcc, 0, v173
    s_cbranch_vccnz Lre_148
Lok_147:
    s_mov_b32 s44, s49
    v_add_u32_dpp v186, v173, v173 quad_perm:[1,0,3,2] row_mask:0xf bank_mask:0xf
    s_nop 1
    v_add_u32_dpp v186, v186, v186 quad_perm:[2,3,0,1] row_mask:0xf bank_mask:0xf
    s_nop 1
    v_add_u32_dpp v186, v186, v186 row_half_mirror row_mask:0xf bank_mask:0xf
    s_bfe_u32 s31, s43, 0x10002
    v_readfirstlane_b32 s30, v186
    s_cmpk_gt_u32 s30, 512
    s_cselect_b32 s30, 1, 0
    s_xor_b32 s30, s30, s31
    s_lshl_b32 s49, s30, 13
    s_add_u32 s49, s49, 16384
Lx_149:
    buffer_load_dwordx4 v[48:51], v20, s[60:63], s49 offen sc1
    buffer_load_dwordx4 v[52:55], v21, s[60:63], s49 offen sc1
    s_waitcnt vmcnt(1)
    v_mfma_f32_16x16x32_bf16 v[148:151], v[48:51], v[48:51], 0
    v_max3_u32 v40, v48, v49, v50
    v_mfma_f32_16x16x32_bf16 v[152:155], v[48:51], v[144:147], 0
    s_waitcnt vmcnt(0)
    v_mfma_f32_16x16x32_bf16 v[148:151], v[52:55], v[52:55], v[148:151]
    v_max3_u32 v40, v40, v51, v52
    v_max3_u32 v40, v40, v53, v54
    v_mfma_f32_16x16x32_bf16 v[152:155], v[52:55], v[144:147], v[152:155]
    v_max_u32 v40, v40, v55
    v_cmp_eq_u32 vcc, -1, v40
    s_nop 3
    v_pk_add_f32 v[40:41], v[148:149], v[150:151]
    v_add_f32 v40, v40, v41
    v_pk_add_f32 v[42:43], v[152:153], v[154:155]
    s_cbranch_vccnz Lre_151
Lok_150:
    s_mov_b32 s30, 229376
    buffer_load_dwordx4 v[44:47], v6, s[56:59], s30 offen sc1
    v_add_f32_dpp v40, v40, v40 quad_perm:[1,0,3,2] row_mask:0xf bank_mask:0xf
    v_add_f32 v42, v42, v43
    s_nop 0
    v_add_f32_dpp v40, v40, v40 quad_perm:[2,3,0,1] row_mask:0xf bank_mask:0xf
    s_nop 1
    v_add_f32_dpp v40, v40, v40 row_half_mirror row_mask:0xf bank_mask:0xf
    s_nop 1
    v_mov_b32_dpp v40, v40 row_ror:8 row_mask:0xc bank_mask:0xf
    v_cndmask_b32 v41, v42, v40, s[88:89]
    v_cndmask_b32 v40, v42, v40, s[88:89]
    s_nop 1
    v_permlane32_swap_b32 v40, v41
    v_add_f32 v42, v40, v41
    v_add_f32 v40, v40, v41
    s_nop 1
    v_permlane16_swap_b32 v40, v42
    v_add_f32 v40, v40, v42
    ds_write_b32 v240, v40 offset:32
Lqp_152:
    s_waitcnt vmcnt(0)
    ds_write_b128 v26, v[44:47]
    v_max3_u32 v40, v44, v45, v46
    v_max_u32 v40, v40, v47
    v_cmp_eq_u32 vcc, -1, v40
    s_cbranch_vccnz Lre_154
Lok_153:
    s_waitcnt lgkmcnt(0)
    s_barrier
    s_mov_b32 s49, s44
    s_mov_b32 s46, 1
    s_mov_b32 s48, 131072
    s_cmp_eq_u32 s26, 0
    s_cselect_b32 s45, 1, 0
    v_add_u32 v32, 32, v32
    v_add_u32 v10, 256, v10
    v_add_u32 v11, 256, v11
    s_branch L_oloop_f
    .p2align 6
Lfin_121:
    s_cmp_lg_u32 s26, 0
    s_cbranch_scc1 Lend_155
    v_pk_add_f32 v[112:113], v[100:101], v[104:105]
    v_pk_add_f32 v[114:115], v[100:101], v[104:105]
    s_nop 1
    v_permlane16_swap_b32 v112, v114
    v_permlane16_swap_b32 v113, v115
    v_pk_add_f32 v[112:113], v[112:113], v[114:115]
    v_cvt_pk_bf16_f32 v44, v112, v113
    buffer_store_dword v44, v27, s[64:67], 0 offen
Lend_155:
    s_endpgm
Lre_105:
    s_sub_u32 s29, s29, 1
    s_cbranch_scc0 Lw_103
    s_mov_b32 s29, 0
    s_branch Lok_104
Lre_108:
    s_sub_u32 s29, s29, 1
    s_cbranch_scc0 Lw_106
    s_mov_b32 s29, 0
    s_branch Lok_107
Lre_111:
    s_sub_u32 s29, s29, 1
    s_cbranch_scc0 Lm_109
    s_mov_b32 s29, 0
    s_branch Lok_110
Lre_115:
    buffer_load_dwordx4 v[188:191], v15, s[56:59], s48 offen sc1
    s_sub_u32 s29, s29, 1
    s_cbranch_scc0 Lo_112
    s_mov_b32 s29, 0
    s_waitcnt vmcnt(0)
    s_branch Lok_114
Lre_119:
    ds_read_b64 v[44:45], v11
    s_sub_u32 s29, s29, 1
    s_cbranch_scc0 Lox_116
    s_mov_b32 s29, 0
    s_waitcnt lgkmcnt(0)
    s_branch Lok_118
Lre_126:
    s_sub_u32 s29, s29, 1
    s_cbranch_scc0 Lr_124
    s_mov_b32 s29, 0
    s_cmp_eq_u32 s45, 1
    s_branch Lok_125
Lre_130:
    s_sub_u32 s29, s29, 1
    s_cbranch_scc0 Lrs_128
    s_mov_b32 s29, 0
    s_branch Lok_129
Lre_133:
    s_sub_u32 s29, s29, 1
    s_cbranch_scc0 Lr_131
    s_mov_b32 s29, 0
    s_cmp_eq_u32 s45, 1
    s_branch Lok_132
Lre_136:
    s_sub_u32 s29, s29, 1
    s_cbranch_scc0 Lrs_134
    s_mov_b32 s29, 0
    s_branch Lok_135
Lre_142:
    s_sub_u32 s29, s29, 1
    s_cbranch_scc0 Lgp_140
    s_mov_b32 s29, 0
    s_branch Lok_141
Lre_145:
    s_sub_u32 s29, s29, 1
    s_cbranch_scc0 Lw_143
    s_mov_b32 s29, 0
    s_branch Lok_144
Lre_148:
    s_sub_u32 s29, s29, 1
    s_cbranch_scc0 Lf2_146
    s_mov_b32 s29, 0
    s_branch Lok_147
Lre_151:
    s_sub_u32 s29, s29, 1
    s_cbranch_scc0 Lx_149
    s_mov_b32 s29, 0
    s_branch Lok_150
Lre_154:
    buffer_load_dwordx4 v[44:47], v6, s[56:59], s30 offen sc1
    s_sub_u32 s29, s29, 1
    s_cbranch_scc0 Lqp_152
    s_mov_b32 s29, 0
    s_waitcnt vmcnt(0)
    s_branch Lok_153
L_code_end:
L_slow_entry:
    s_cmp_ge_u32 s27, 16
    s_cbranch_scc1 Lsq_156
    buffer_store_dwordx2 v[178:179], v177, s[60:63], s42 offen sc1
Lsq_156:
    v_mov_b32 v156, -1
    v_mov_b32 v157, -1
    v_mov_b32 v158, -1
    v_mov_b32 v159, -1
    s_cmp_lg_u32 s28, 0
    s_cbranch_scc1 Lnl_157
    s_cmp_lg_u32 s27, 16
    s_cbranch_scc1 Lnl_157
    v_xor_b32 v186, v186, v175
    v_cmp_eq_u32 vcc, 0, v186
    s_bcnt1_i32_b64 s30, vcc
    v_cmp_eq_u32 vcc, 1, v186
    s_bcnt1_i32_b64 s31, vcc
    s_sub_u32 s30, s31, s30
    s_max_i32 s30, s30, -63
    s_add_u32 s30, s30, 64
    v_mov_b32 v186, s30
    buffer_store_dword v186, v5, s[52:55], s41 offen offset:128 sc1
    s_add_u32 s30, s39, 4096
    buffer_store_dword v175, v5, s[60:63], s30 offen sc1
Lnl_157:
    s_cmp_lt_u32 s27, 12
    s_cbranch_scc1 Lp_158
    s_cmp_ge_u32 s27, 16
    s_cbranch_scc1 Lp_159
    s_lshl_b32 s30, s27, 14
    s_lshl_b32 s31, s28, 12
    s_add_u32 s30, s30, s31
    buffer_store_dwordx4 v[156:159], v12, s[56:59], s30 offen offset:0 sc1
    buffer_store_dwordx4 v[156:159], v12, s[56:59], s30 offen offset:1024 sc1
    buffer_store_dwordx4 v[156:159], v12, s[56:59], s30 offen offset:2048 sc1
    buffer_store_dwordx4 v[156:159], v12, s[56:59], s30 offen offset:3072 sc1
    s_branch Lp_158
Lp_159:
    s_mul_i32 s30, s34, 12288
    s_mul_i32 s31, s28, 3072
    s_add_u32 s30, s30, s31
    buffer_store_dwordx4 v[156:159], v12, s[56:59], s30 offen offset:0 sc1
    buffer_store_dwordx4 v[156:159], v12, s[56:59], s30 offen offset:1024 sc1
    buffer_store_dwordx4 v[156:159], v12, s[56:59], s30 offen offset:2048 sc1
Lp_158:
    s_waitcnt vmcnt(0)
    s_lshl_b32 s30, s27, 5
    s_lshl_b32 s31, s28, 2
    s_add_u32 s30, s30, s31
    s_add_u32 s30, s30, s39
    buffer_store_dword v175, v5, s[60:63], s30 offen offset:16 sc1
Lr2_160:
    buffer_load_dwordx4 v[156:159], v35, s[60:63], s39 offen offset:16 sc1
    buffer_load_dwordx4 v[40:43], v151, s[60:63], s42 offen sc1
    buffer_load_dwordx4 v[44:47], v151, s[60:63], s42 offen offset:1024 sc1
    s_waitcnt vmcnt(0)
    ds_write2_b32 v152, v40, v42 offset0:0 offset1:1
    ds_write2_b32 v152, v44, v46 offset0:144 offset1:145
    v_xor_b32 v156, v156, v175
    v_xor_b32 v157, v157, v175
    v_xor_b32 v158, v158, v175
    v_xor_b32 v159, v159, v175
    v_xor_b32 v41, v41, v175
    v_xor_b32 v43, v43, v175
    v_xor_b32 v45, v45, v175
    v_xor_b32 v47, v47, v175
    v_or3_b32 v41, v41, v43, v45
    v_or3_b32 v41, v41, v47, v156
    v_or3_b32 v41, v41, v157, v158
    v_or_b32 v41, v41, v159
    v_cmp_ne_u32 vcc, 0, v41
    s_cbranch_vccnz Lre_162
Lok_161:
    v_mov_b32 v44, 2
    ds_write_b32 v28, v44 offset:0
    s_waitcnt lgkmcnt(0)
    s_barrier
L_loops_s:
    global_load_dword v184, v154, s[16:17]
    global_load_dword v185, v153, s[18:19]
    s_cmp_ge_u32 s27, 16
    s_cbranch_scc1 L_o_s
    s_call_b64 s[90:91], L_centre
    s_mov_b32 s64, s16
    s_mov_b32 s65, s17
    s_mov_b32 s66, 1605632
    s_mov_b32 s67, 0x20000
    s_mov_b32 s36, s18
    s_mov_b32 s37, s19
    s_mov_b32 s38, 1605632
    s_mov_b32 s39, 0x20000
    v_lshrrev_b32 v13, 1, v2
    v_mul_u32_u24 v13, 3584, v13
    v_and_b32 v14, 1, v2
    v_lshl_add_u32 v13, v14, 4, v13
    s_mul_i32 s32, s26, 14
    s_add_u32 s32, s32, s27
    s_mul_i32 s31, s28, 229376
    v_add_u32 v13, s31, v13
    v_add_u32 v15, 917504, v13
    s_mul_i32 s33, s28, 16896
    s_mul_i32 s30, s32, 14336
    v_lshl_add_u32 v14, v1, 8, v9
    v_cmp_gt_u32 vcc, 896, v14
    s_nop 1
    v_cndmask_b32 v14, v25, v14, vcc
    v_lshlrev_b32 v16, 4, v3
    v_lshl_add_u32 v16, v1, 8, v16
    v_cmp_gt_u32 vcc, 896, v16
    v_mul_u32_u24 v17, 896, v4
    v_add_u32 v16, v16, v17
    v_cndmask_b32 v16, v25, v16, vcc
    v_and_b32 v46, 31, v9
    s_cmp_ge_u32 s27, 14
    s_cbranch_scc1 Lnf_163
    s_lshl_b32 s40, s32, 5
Lw_165:
    ds_read_b128 v[40:43], v28 offset:112
    s_waitcnt lgkmcnt(0)
    v_max3_u32 v40, v40, v41, v42
    v_max_u32 v40, v40, v43
    v_cmp_eq_u32 vcc, -1, v40
    s_cbranch_vccnz Lre_167
Lok_166:
    s_add_u32 m0, s33, 0
    s_add_u32 s31, s40, 0
    buffer_load_dwordx4 v13, s[64:67], s31 offen lds
    s_add_u32 m0, s33, 1024
    s_add_u32 s31, s40, 114688
    buffer_load_dwordx4 v13, s[64:67], s31 offen lds
    s_add_u32 m0, s33, 2048
    s_add_u32 s31, s40, 0
    buffer_load_dwordx4 v15, s[64:67], s31 offen lds
    s_add_u32 m0, s33, 3072
    s_add_u32 s31, s40, 114688
    buffer_load_dwordx4 v15, s[64:67], s31 offen lds
    buffer_load_dword v128, v14, s[36:39], s30 offen offset:0
    buffer_load_dword v129, v14, s[36:39], s30 offen offset:896
    buffer_load_dword v130, v14, s[36:39], s30 offen offset:1792
    buffer_load_dword v131, v14, s[36:39], s30 offen offset:2688
    s_add_u32 s30, s30, 3584
    buffer_load_dword v132, v14, s[36:39], s30 offen offset:0
    buffer_load_dword v133, v14, s[36:39], s30 offen offset:896
    buffer_load_dword v134, v14, s[36:39], s30 offen offset:1792
    buffer_load_dword v135, v14, s[36:39], s30 offen offset:2688
    s_add_u32 s30, s30, 3584
    buffer_load_dword v136, v14, s[36:39], s30 offen offset:0
    buffer_load_dword v137, v14, s[36:39], s30 offen offset:896
    buffer_load_dword v138, v14, s[36:39], s30 offen offset:1792
    buffer_load_dword v139, v14, s[36:39], s30 offen offset:2688
    s_add_u32 s30, s30, 3584
    buffer_load_dword v140, v14, s[36:39], s30 offen offset:0
    buffer_load_dword v141, v14, s[36:39], s30 offen offset:896
    buffer_load_dword v142, v14, s[36:39], s30 offen offset:1792
    buffer_load_dword v143, v14, s[36:39], s30 offen offset:2688
    buffer_load_dword v173, v46, s[52:55], 0 offen offset:128 sc1
    v_lshlrev_b32 v13, 8, v4
    v_lshl_add_u32 v13, v3, 3, v13
    v_add_u32 v13, s33, v13
    v_add_u32 v14, s33, v9
    s_mov_b32 s30, 0x05040100
    s_mov_b32 s31, 0x07060302
    s_waitcnt vmcnt(0)
    ds_read_b64_tr_b16 v[96:97], v13 offset:0
    ds_read_b64_tr_b16 v[98:99], v13 offset:128
    ds_read_b64_tr_b16 v[100:101], v13 offset:1024
    ds_read_b64_tr_b16 v[102:103], v13 offset:1152
    ds_read_b64_tr_b16 v[104:105], v13 offset:2048
    ds_read_b64_tr_b16 v[106:107], v13 offset:2176
    ds_read_b64_tr_b16 v[108:109], v13 offset:3072
    ds_read_b64_tr_b16 v[110:111], v13 offset:3200
    v_perm_b32 v112, v129, v128, s30
    v_perm_b32 v113, v129, v128, s31
    v_perm_b32 v114, v131, v130, s30
    v_perm_b32 v115, v131, v130, s31
    v_perm_b32 v116, v133, v132, s30
    v_perm_b32 v117, v133, v132, s31
    v_perm_b32 v118, v135, v134, s30
    v_perm_b32 v119, v135, v134, s31
    v_perm_b32 v120, v137, v136, s30
    v_perm_b32 v121, v137, v136, s31
    v_perm_b32 v122, v139, v138, s30
    v_perm_b32 v123, v139, v138, s31
    v_perm_b32 v124, v141, v140, s30
    v_perm_b32 v125, v141, v140, s31
    v_perm_b32 v126, v143, v142, s30
    v_perm_b32 v127, v143, v142, s31
    s_waitcnt lgkmcnt(0)
    v_mfma_f32_16x16x32_bf16 v[156:159], v[144:147], v[96:99], 0
    v_mfma_f32_16x16x32_bf16 v[156:159], v[144:147], v[100:103], v[156:159]
    v_mfma_f32_16x16x32_bf16 v[156:159], v[144:147], v[104:107], v[156:159]
    v_mfma_f32_16x16x32_bf16 v[156:159], v[144:147], v[108:111], v[156:159]
    s_nop 7
    ds_write_b32 v30, v156
    ds_read_b128 v[152:155], v33 offset:16
    ds_read_b128 v[148:151], v33
    ds_read_b128 v[44:47], v32
Ls_168:
    s_waitcnt lgkmcnt(2)
    v_pk_add_f32 v[152:153], v[152:153], v[154:155]
    s_waitcnt lgkmcnt(1)
    v_pk_add_f32 v[148:149], v[148:149], v[150:151]
    v_add_f32 v152, v152, v153
    v_add_f32 v148, v148, v149
    s_waitcnt lgkmcnt(0)
    v_pk_add_f32 v[44:45], v[44:45], v[46:47]
    v_add_f32 v44, v44, v45
    v_max3_u32 v45, v44, v148, v152
    v_cmp_eq_u32 vcc, -1, v45
    s_cbranch_vccnz Lre_170
Lok_169:
    v_mov_b32 v39, v44
    v_add_u32 v30, 640, v30
    v_add_u32 v32, 640, v32
    v_add_u32 v33, 640, v33
    v_cmp_eq_u32 vcc, 0, v173
    s_cbranch_vccz Lf_164
    s_branch Lk_171
Lnf_163:
Lw_172:
    ds_read_b128 v[40:43], v28 offset:112
    s_waitcnt lgkmcnt(0)
    v_max3_u32 v40, v40, v41, v42
    v_max_u32 v40, v40, v43
    v_cmp_eq_u32 vcc, -1, v40
    s_cbranch_vccnz Lre_174
Lok_173:
    v_and_b32 v16, 31, v2
    v_lshlrev_b32 v16, 7, v16
    s_and_b32 s30, s27, 1
    s_lshl_b32 s30, s30, 2
    s_add_u32 s30, s30, s28
    s_lshl_b32 s30, s30, 12
    s_add_u32 s30, s30, 65536
Lkp_175:
    buffer_load_dword v40, v16, s[56:59], s30 offen sc1
    buffer_load_dword v41, v31, s[56:59], 0 offen sc1
    s_waitcnt vmcnt(0)
    v_cmp_eq_u32 vcc, -1, v41
    s_cbranch_vccnz Lre_177
Lok_176:
    s_add_u32 s30, s30, 131072
    s_mov_b32 s31, 229376
    buffer_load_dword v40, v16, s[56:59], s30 offen sc1
    buffer_load_dword v40, v6, s[56:59], s31 offen sc1
    s_waitcnt vmcnt(0)
Lk_171:
    v_and_b32 v46, 31, v9
Lf2_178:
    buffer_load_dword v173, v46, s[52:55], 0 offen offset:128 sc1
    s_waitcnt vmcnt(0)
    v_cmp_eq_u32 vcc, 0, v173
    s_cbranch_vccnz Lre_180
Lok_179:
Lf_164:
    v_add_u32_dpp v186, v173, v173 quad_perm:[1,0,3,2] row_mask:0xf bank_mask:0xf
    s_nop 1
    v_add_u32_dpp v186, v186, v186 quad_perm:[2,3,0,1] row_mask:0xf bank_mask:0xf
    s_nop 1
    v_add_u32_dpp v186, v186, v186 row_half_mirror row_mask:0xf bank_mask:0xf
    s_bfe_u32 s31, s43, 0x10002
    v_readfirstlane_b32 s30, v186
    s_cmpk_gt_u32 s30, 512
    s_cselect_b32 s30, 1, 0
    s_xor_b32 s30, s30, s31
    s_lshl_b32 s49, s30, 13
    .p2align 6
L_qloop_s:
    s_cmp_ge_u32 s27, 14
    s_cbranch_scc1 Lskip_181
    s_cmp_lg_u32 s28, 0
    s_cbranch_scc1 Lgo_183
Lgp_182:
    buffer_load_dword v40, v31, s[56:59], s48 offen offset:0 sc1
    s_waitcnt vmcnt(0)
    v_cmp_eq_u32 vcc, -1, v40
    s_cbranch_vccnz Lre_185
Lok_184:
    ds_write_b32 v29, v37 offset:0
Lgo_183:
Lw_186:
    ds_read_b32 v40, v29 offset:0
    s_waitcnt lgkmcnt(0)
    v_cmp_eq_u32 vcc, -1, v40
    s_cbranch_vccnz Lre_188
Lok_187:
    s_add_u32 s44, s48, 102400
    v_mov_b32 v128, 0
    v_mov_b32 v129, 0
    v_mov_b32 v130, 0
    v_mov_b32 v131, 0
Lx_189:
    buffer_load_dwordx4 v[48:51], v20, s[60:63], s49 offen sc1
    buffer_load_dwordx4 v[52:55], v21, s[60:63], s49 offen sc1
    s_nop 3
    v_mov_b32 v156, 0
    v_mov_b32 v157, 0
    v_mov_b32 v158, 0
    v_mov_b32 v159, 0
    s_waitcnt vmcnt(1)
    v_mfma_f32_16x16x32_bf16 v[148:151], v[48:51], v[48:51], 0
    v_max3_u32 v40, v48, v49, v50
    v_mfma_f32_16x16x32_bf16 v[152:155], v[48:51], v[144:147], 0
    s_waitcnt vmcnt(0)
    v_mfma_f32_16x16x32_bf16 v[148:151], v[52:55], v[52:55], v[148:151]
    v_max3_u32 v40, v40, v51, v52
    v_max3_u32 v40, v40, v53, v54
    v_mfma_f32_16x16x32_bf16 v[152:155], v[52:55], v[144:147], v[152:155]
    v_max_u32 v40, v40, v55
    v_cmp_eq_u32 vcc, -1, v40
    v_smfmac_f32_16x16x64_bf16 v[156:159], v[48:51], v[96:103], v183
    v_smfmac_f32_16x16x64_bf16 v[156:159], v[52:55], v[104:111], v183
    s_nop 0
    v_pk_add_f32 v[40:41], v[148:149], v[150:151]
    v_add_f32 v40, v40, v41
    s_nop 0
    v_pk_add_f32 v[42:43], v[152:153], v[154:155]
    s_cbranch_vccnz Lre_191
Lok_190:
    v_add_f32_dpp v40, v40, v40 quad_perm:[1,0,3,2] row_mask:0xf bank_mask:0xf
    v_add_f32 v42, v42, v43
    s_nop 0
    v_add_f32_dpp v40, v40, v40 quad_perm:[2,3,0,1] row_mask:0xf bank_mask:0xf
    v_pk_add_f32 v[156:157], v[156:157], v[158:159]
    s_nop 0
    v_add_f32_dpp v40, v40, v40 row_half_mirror row_mask:0xf bank_mask:0xf
    v_add_f32 v44, v156, v157
    s_nop 0
    v_mov_b32_dpp v40, v40 row_ror:8 row_mask:0xc bank_mask:0xf
    v_cndmask_b32 v40, v42, v40, s[88:89]
    s_nop 0
    s_nop 0
    v_permlane32_swap_b32 v44, v40
    v_add_f32 v45, v44, v40
    v_add_f32 v44, v44, v40
    s_nop 1
    v_permlane16_swap_b32 v44, v45
    v_add_f32 v44, v44, v45
    ds_write_b32 v30, v44
    ds_read_b128 v[152:155], v33 offset:16
    ds_read_b128 v[148:151], v33
    ds_read_b128 v[44:47], v32
Ls_192:
    s_waitcnt lgkmcnt(2)
    v_pk_add_f32 v[152:153], v[152:153], v[154:155]
    s_waitcnt lgkmcnt(1)
    v_pk_add_f32 v[148:149], v[148:149], v[150:151]
    v_add_f32 v152, v152, v153
    v_add_f32 v148, v148, v149
    v_mul_f32 v42, s47, v152
    v_fma_f32 v43, v148, s47, v187
    s_waitcnt lgkmcnt(0)
    v_pk_add_f32 v[44:45], v[44:45], v[46:47]
    v_fma_f32 v43, -v42, v42, v43
    v_add_f32 v44, v44, v45
    v_max_f32 v43, v187, v43
    v_max3_u32 v45, v44, v148, v152
    v_cmp_eq_u32 vcc, -1, v45
    v_rsq_f32 v43, v43
    v_fma_f32 v41, -v42, v39, v44
    v_mul_f32 v41, v41, v43
    v_mul_f32 v42, 0xbfb8aa3b, v41
    v_exp_f32 v42, v42
    s_cbranch_vccnz Lre_194
Lok_193:
    v_add_f32 v42, 1.0, v42
    v_rcp_f32 v42, v42
    s_nop 0
    v_mul_f32 v41, v41, v42
    s_nop 1
    v_mov_b32_dpp v42, v41 quad_perm:[1,0,3,2] row_mask:0xf bank_mask:0xf
    v_cvt_pk_bf16_f32 v41, v41, v42
    s_nop 1
    v_dot2c_f32_bf16_dpp v128, v41, v112 row_newbcast:0 row_mask:0xf bank_mask:0xf
    v_dot2c_f32_bf16_dpp v129, v41, v113 row_newbcast:0 row_mask:0xf bank_mask:0xf
    v_dot2c_f32_bf16_dpp v130, v41, v114 row_newbcast:2 row_mask:0xf bank_mask:0xf
    v_dot2c_f32_bf16_dpp v131, v41, v115 row_newbcast:2 row_mask:0xf bank_mask:0xf
    v_dot2c_f32_bf16_dpp v128, v41, v116 row_newbcast:4 row_mask:0xf bank_mask:0xf
    v_dot2c_f32_bf16_dpp v129, v41, v117 row_newbcast:4 row_mask:0xf bank_mask:0xf
    v_dot2c_f32_bf16_dpp v130, v41, v118 row_newbcast:6 row_mask:0xf bank_mask:0xf
    v_dot2c_f32_bf16_dpp v131, v41, v119 row_newbcast:6 row_mask:0xf bank_mask:0xf
    v_dot2c_f32_bf16_dpp v128, v41, v120 row_newbcast:8 row_mask:0xf bank_mask:0xf
    v_dot2c_f32_bf16_dpp v129, v41, v121 row_newbcast:8 row_mask:0xf bank_mask:0xf
    v_dot2c_f32_bf16_dpp v130, v41, v122 row_newbcast:10 row_mask:0xf bank_mask:0xf
    v_dot2c_f32_bf16_dpp v131, v41, v123 row_newbcast:10 row_mask:0xf bank_mask:0xf
    v_dot2c_f32_bf16_dpp v128, v41, v124 row_newbcast:12 row_mask:0xf bank_mask:0xf
    v_dot2c_f32_bf16_dpp v129, v41, v125 row_newbcast:12 row_mask:0xf bank_mask:0xf
    v_dot2c_f32_bf16_dpp v130, v41, v126 row_newbcast:14 row_mask:0xf bank_mask:0xf
    v_dot2c_f32_bf16_dpp v131, v41, v127 row_newbcast:14 row_mask:0xf bank_mask:0xf
    s_nop 2
    v_pk_add_f32 v[128:129], v[128:129], v[130:131]
    buffer_store_dwordx2 v[128:129], v18, s[56:59], s44 offen sc1
    v_add_u32 v30, 640, v30
    v_add_u32 v32, 640, v32
    v_add_u32 v33, 640, v33
Lskip_181:
    s_cmp_lg_u32 s46, 0
    s_cbranch_scc1 Lqe_195
    s_add_u32 s49, s49, 16384
    s_cmp_lg_u32 s28, 0
    s_cbranch_scc1 Lgo_197
Lgp_196:
    buffer_load_dword v40, v31, s[56:59], s48 offen offset:1024 sc1
    s_waitcnt vmcnt(0)
    v_cmp_eq_u32 vcc, -1, v40
    s_cbranch_vccnz Lre_199
Lok_198:
    ds_write_b32 v29, v37 offset:4
Lgo_197:
Lw_200:
    ds_read_b32 v40, v29 offset:4
    s_waitcnt lgkmcnt(0)
    v_cmp_eq_u32 vcc, -1, v40
    s_cbranch_vccnz Lre_202
Lok_201:
    s_mov_b32 s44, 229376
Lqf_203:
    buffer_load_dwordx4 v[56:59], v22, s[60:63], s49 offen sc1
    buffer_load_dwordx4 v[60:63], v23, s[60:63], s49 offen sc1
    s_nop 3
    v_mov_b32 v156, 0
    v_mov_b32 v157, 0
    v_mov_b32 v158, 0
    v_mov_b32 v159, 0
    v_mov_b32 v160, 0
    v_mov_b32 v161, 0
    v_mov_b32 v162, 0
    v_mov_b32 v163, 0
    s_waitcnt vmcnt(1)
    v_smfmac_f32_16x16x64_bf16 v[156:159], v[56:59], v[64:71], v183
    v_max3_u32 v40, v56, v57, v58
    v_smfmac_f32_16x16x64_bf16 v[160:163], v[56:59], v[80:87], v183
    s_waitcnt vmcnt(0)
    v_smfmac_f32_16x16x64_bf16 v[156:159], v[60:63], v[72:79], v183
    v_max3_u32 v40, v40, v59, v60
    v_max3_u32 v40, v40, v61, v62
    v_smfmac_f32_16x16x64_bf16 v[160:163], v[60:63], v[88:95], v183
    v_max_u32 v40, v40, v63
    v_cmp_eq_u32 vcc, -1, v40
    s_nop 2
    v_pk_add_f32 v[156:157], v[156:157], v[158:159]
    s_nop 1
    v_pk_add_f32 v[160:161], v[160:161], v[162:163]
    v_add_f32 v156, v156, v157
    v_add_f32 v160, v160, v161
    s_cbranch_vccnz Lre_205
Lok_204:
    s_nop 0
    v_permlane32_swap_b32 v156, v160
    v_add_f32 v44, v156, v160
    v_add_f32 v46, v156, v160
    s_nop 1
    v_permlane16_swap_b32 v44, v46
    v_add_f32 v41, v44, v46
    s_nop 1
    v_mov_b32_dpp v42, v41 quad_perm:[1,0,3,2] row_mask:0xf bank_mask:0xf
    v_cvt_pk_bf16_f32 v42, v41, v42
    buffer_store_dword v42, v24, s[56:59], s44 offen sc1
Lx_206:
    buffer_load_dwordx4 v[48:51], v20, s[60:63], s49 offen sc1
    buffer_load_dwordx4 v[52:55], v21, s[60:63], s49 offen sc1
    s_waitcnt vmcnt(1)
    v_mfma_f32_16x16x32_bf16 v[148:151], v[48:51], v[48:51], 0
    v_max3_u32 v40, v48, v49, v50
    v_mfma_f32_16x16x32_bf16 v[152:155], v[48:51], v[144:147], 0
    s_waitcnt vmcnt(0)
    v_mfma_f32_16x16x32_bf16 v[148:151], v[52:55], v[52:55], v[148:151]
    v_max3_u32 v40, v40, v51, v52
    v_max3_u32 v40, v40, v53, v54
    v_mfma_f32_16x16x32_bf16 v[152:155], v[52:55], v[144:147], v[152:155]
    v_max_u32 v40, v40, v55
    v_cmp_eq_u32 vcc, -1, v40
    s_nop 3
    v_pk_add_f32 v[40:41], v[148:149], v[150:151]
    v_add_f32 v40, v40, v41
    v_pk_add_f32 v[42:43], v[152:153], v[154:155]
    s_cbranch_vccnz Lre_208
Lok_207:
    s_mov_b32 s30, 229376
    buffer_load_dwordx4 v[44:47], v6, s[56:59], s30 offen sc1
    v_add_f32_dpp v40, v40, v40 quad_perm:[1,0,3,2] row_mask:0xf bank_mask:0xf
    v_add_f32 v42, v42, v43
    s_nop 0
    v_add_f32_dpp v40, v40, v40 quad_perm:[2,3,0,1] row_mask:0xf bank_mask:0xf
    s_nop 1
    v_add_f32_dpp v40, v40, v40 row_half_mirror row_mask:0xf bank_mask:0xf
    s_nop 1
    v_mov_b32_dpp v40, v40 row_ror:8 row_mask:0xc bank_mask:0xf
    v_cndmask_b32 v41, v42, v40, s[88:89]
    v_cndmask_b32 v40, v42, v40, s[88:89]
    s_nop 1
    v_permlane32_swap_b32 v40, v41
    v_add_f32 v42, v40, v41
    v_add_f32 v40, v40, v41
    s_nop 1
    v_permlane16_swap_b32 v40, v42
    v_add_f32 v40, v40, v42
    ds_write_b32 v240, v40 offset:32
Lqp_209:
    s_waitcnt vmcnt(0)
    ds_write_b128 v26, v[44:47]
    v_max3_u32 v40, v44, v45, v46
    v_max_u32 v40, v40, v47
    v_cmp_eq_u32 vcc, -1, v40
    s_cbranch_vccnz Lre_211
Lok_210:
    s_waitcnt lgkmcnt(0)
    s_barrier
    s_mov_b32 s46, 1
    s_mov_b32 s48, 131072
    s_add_u32 s49, s49, 16384
    v_add_u32 v29, 8, v29
    s_branch L_qloop_s
Lqe_195:
    s_endpgm
Lre_162:
    s_sub_u32 s29, s29, 1
    s_cbranch_scc0 Lr2_160
    s_mov_b32 s29, 0
    s_branch Lok_161
Lre_167:
    s_sub_u32 s29, s29, 1
    s_cbranch_scc0 Lw_165
    s_mov_b32 s29, 0
    s_branch Lok_166
Lre_170:
    ds_read_b128 v[152:155], v33 offset:16
    ds_read_b128 v[148:151], v33
    ds_read_b128 v[44:47], v32
    s_sub_u32 s29, s29, 1
    s_cbranch_scc0 Ls_168
    s_mov_b32 s29, 0
    s_waitcnt lgkmcnt(0)
    s_branch Lok_169
Lre_174:
    s_sub_u32 s29, s29, 1
    s_cbranch_scc0 Lw_172
    s_mov_b32 s29, 0
    s_branch Lok_173
Lre_177:
    s_sub_u32 s29, s29, 1
    s_cbranch_scc0 Lkp_175
    s_mov_b32 s29, 0
    s_branch Lok_176
Lre_180:
    s_sub_u32 s29, s29, 1
    s_cbranch_scc0 Lf2_178
    s_mov_b32 s29, 0
    s_branch Lok_179
Lre_185:
    s_sub_u32 s29, s29, 1
    s_cbranch_scc0 Lgp_182
    s_mov_b32 s29, 0
    s_branch Lok_184
Lre_188:
    s_sub_u32 s29, s29, 1
    s_cbranch_scc0 Lw_186
    s_mov_b32 s29, 0
    s_branch Lok_187
Lre_191:
    s_sub_u32 s29, s29, 1
    s_cbranch_scc0 Lx_189
    s_mov_b32 s29, 0
    s_branch Lok_190
Lre_194:
    ds_read_b128 v[152:155], v33 offset:16
    ds_read_b128 v[148:151], v33
    ds_read_b128 v[44:47], v32
    s_sub_u32 s29, s29, 1
    s_cbranch_scc0 Ls_192
    s_mov_b32 s29, 0
    s_waitcnt lgkmcnt(0)
    s_branch Lok_193
Lre_199:
    s_sub_u32 s29, s29, 1
    s_cbranch_scc0 Lgp_196
    s_mov_b32 s29, 0
    s_branch Lok_198
Lre_202:
    s_sub_u32 s29, s29, 1
    s_cbranch_scc0 Lw_200
    s_mov_b32 s29, 0
    s_branch Lok_201
Lre_205:
    s_sub_u32 s29, s29, 1
    s_cbranch_scc0 Lqf_203
    s_mov_b32 s29, 0
    s_branch Lok_204
Lre_208:
    s_sub_u32 s29, s29, 1
    s_cbranch_scc0 Lx_206
    s_mov_b32 s29, 0
    s_branch Lok_207
Lre_211:
    buffer_load_dwordx4 v[44:47], v6, s[56:59], s30 offen sc1
    s_sub_u32 s29, s29, 1
    s_cbranch_scc0 Lqp_209
    s_mov_b32 s29, 0
    s_waitcnt vmcnt(0)
    s_branch Lok_210
L_o_s:
    buffer_load_dword v180, v15, s[56:59], 0 offen sc1
Lw_212:
    ds_read_b128 v[44:47], v28 offset:64
    s_waitcnt lgkmcnt(0)
    v_max3_u32 v44, v44, v45, v46
    v_max_u32 v44, v44, v47
    v_cmp_eq_u32 vcc, -1, v44
    s_cbranch_vccnz Lre_214
Lok_213:
    v_and_b32 v182, 31, v9
    .p2align 6
L_oloop_s:
    v_mov_b32 v123, 0
    v_mov_b32 v228, -1
    v_mov_b32 v229, -1
    v_mov_b32 v230, -1
    v_mov_b32 v231, -1
    v_mov_b32 v124, -1
    v_mov_b32 v125, -1
    v_mov_b32 v126, -1
    v_mov_b32 v127, -1
Lw_215:
    ds_read_b128 v[44:47], v32 offset:0
    s_waitcnt lgkmcnt(0)
    v_max3_u32 v44, v44, v45, v46
    v_max_u32 v44, v44, v47
    v_cmp_eq_u32 vcc, -1, v44
    s_cbranch_vccnz Lre_217
Lok_216:
Lm_218:
    buffer_load_dwordx4 v[40:43], v7, s[56:59], s48 offen sc1
    buffer_load_dword v180, v15, s[56:59], s48 offen sc1
    s_waitcnt vmcnt(1)
    v_max3_u32 v44, v40, v41, v42
    v_max_u32 v44, v44, v43
    v_cmp_eq_u32 vcc, -1, v44
    v_max3_f32 v40, v40, v41, v42
    v_max_f32 v40, v40, v43
    s_cbranch_vccnz Lre_220
Lok_219:
    buffer_load_dwordx4 v[188:191], v15, s[56:59], s48 offen sc1
    v_mov_b32 v41, v40
    v_mov_b32 v42, v40
    v_max_f32_dpp v40, v40, v40 row_ror:8 row_mask:0xf bank_mask:0xf
    s_nop 0
    v_permlane16_swap_b32 v41, v42
    v_max_f32_dpp v40, v40, v40 row_ror:4 row_mask:0xf bank_mask:0xf
    s_nop 0
    v_mov_b32_dpp v41, v41 row_ror:8 row_mask:0xf bank_mask:0xc
    v_max_f32_dpp v40, v40, v40 row_ror:2 row_mask:0xf bank_mask:0xf
    s_nop 1
    v_max_f32_dpp v40, v40, v40 row_ror:1 row_mask:0xf bank_mask:0xf
    v_mov_b32 v45, v40
    s_nop 1
    v_permlane16_swap_b32 v40, v45
    v_max_f32 v40, v40, v45
    v_sub_f32 v41, v41, v40
    v_exp_f32 v41, v41
    s_add_u32 s31, s48, 94208
    s_add_u32 s30, s48, 65536
Lo_221:
    s_waitcnt vmcnt(0)
    v_max3_u32 v44, v188, v189, v190
    v_max_u32 v44, v44, v191
    v_cmp_eq_u32 vcc, -1, v44
    v_mul_f32 v132, v41, v188
    v_mul_f32 v133, v41, v189
    v_mul_f32 v134, v41, v190
    v_mul_f32 v135, v41, v191
    v_add_f32_dpp v132, v132, v132 quad_perm:[1,0,3,2] row_mask:0xf bank_mask:0xf
    v_add_f32_dpp v133, v133, v133 quad_perm:[1,0,3,2] row_mask:0xf bank_mask:0xf
    v_add_f32_dpp v134, v134, v134 quad_perm:[1,0,3,2] row_mask:0xf bank_mask:0xf
    v_add_f32_dpp v135, v135, v135 quad_perm:[1,0,3,2] row_mask:0xf bank_mask:0xf
    s_cbranch_vccnz Lre_224
Lok_223:
    v_add_f32_dpp v132, v132, v132 quad_perm:[2,3,0,1] row_mask:0xf bank_mask:0xf
    v_add_f32_dpp v133, v133, v133 quad_perm:[2,3,0,1] row_mask:0xf bank_mask:0xf
    v_add_f32_dpp v134, v134, v134 quad_perm:[2,3,0,1] row_mask:0xf bank_mask:0xf
    v_add_f32_dpp v135, v135, v135 quad_perm:[2,3,0,1] row_mask:0xf bank_mask:0xf
    v_add_f32_dpp v132, v132, v132 row_half_mirror row_mask:0xf bank_mask:0xf
    v_add_f32_dpp v133, v133, v133 row_half_mirror row_mask:0xf bank_mask:0xf
    v_add_f32_dpp v134, v134, v134 row_half_mirror row_mask:0xf bank_mask:0xf
    v_add_f32_dpp v135, v135, v135 row_half_mirror row_mask:0xf bank_mask:0xf
    v_cvt_pk_bf16_f32 v46, v132, v133
    v_cvt_pk_bf16_f32 v47, v134, v135
    ds_write_b64 v10, v[46:47]
    s_cmp_lg_u32 s28, s3
    ds_read_b64 v[44:45], v11
    s_cbranch_scc1 Lnl_226
    buffer_load_dword v123, v182, s[52:55], 0 offen offset:128 sc1
    buffer_load_dwordx4 v[228:231], v12, s[56:59], s31 offen sc1
    buffer_load_dwordx4 v[124:127], v12, s[56:59], s31 offen offset:1024 sc1
Lnl_226:
Lox_225:
    s_waitcnt lgkmcnt(0)
    v_max_u32 v46, v44, v45
    v_cmp_eq_u32 vcc, -1, v46
    v_mfma_f32_4x4x4_16b_bf16 v[128:131], v[44:45], v[64:65], 0 cbsz:4 abid:0
    v_mfma_f32_4x4x4_16b_bf16 v[136:139], v[44:45], v[80:81], 0 cbsz:4 abid:0
    v_mfma_f32_4x4x4_16b_bf16 v[132:135], v[44:45], v[66:67], 0 cbsz:4 abid:1
    v_mfma_f32_4x4x4_16b_bf16 v[140:143], v[44:45], v[82:83], 0 cbsz:4 abid:1
    s_cbranch_vccnz Lre_228
Lok_227:
    v_mfma_f32_4x4x4_16b_bf16 v[128:131], v[44:45], v[68:69], v[128:131] cbsz:4 abid:2
    v_mfma_f32_4x4x4_16b_bf16 v[136:139], v[44:45], v[84:85], v[136:139] cbsz:4 abid:2
    v_mfma_f32_4x4x4_16b_bf16 v[132:135], v[44:45], v[70:71], v[132:135] cbsz:4 abid:3
    v_mfma_f32_4x4x4_16b_bf16 v[140:143], v[44:45], v[86:87], v[140:143] cbsz:4 abid:3
    v_mfma_f32_4x4x4_16b_bf16 v[128:131], v[44:45], v[72:73], v[128:131] cbsz:4 abid:4
    v_mfma_f32_4x4x4_16b_bf16 v[136:139], v[44:45], v[88:89], v[136:139] cbsz:4 abid:4
    v_mfma_f32_4x4x4_16b_bf16 v[132:135], v[44:45], v[74:75], v[132:135] cbsz:4 abid:5
    v_mfma_f32_4x4x4_16b_bf16 v[140:143], v[44:45], v[90:91], v[140:143] cbsz:4 abid:5
    v_mfma_f32_4x4x4_16b_bf16 v[128:131], v[44:45], v[76:77], v[128:131] cbsz:4 abid:6
    v_mfma_f32_4x4x4_16b_bf16 v[136:139], v[44:45], v[92:93], v[136:139] cbsz:4 abid:6
    v_mfma_f32_4x4x4_16b_bf16 v[132:135], v[44:45], v[78:79], v[132:135] cbsz:4 abid:7
    v_mfma_f32_4x4x4_16b_bf16 v[140:143], v[44:45], v[94:95], v[140:143] cbsz:4 abid:7
    s_nop 1
    v_pk_add_f32 v[128:129], v[128:129], v[130:131]
    v_pk_add_f32 v[136:137], v[136:137], v[138:139]
    v_pk_add_f32 v[132:133], v[132:133], v[134:135]
    v_pk_add_f32 v[140:141], v[140:141], v[142:143]
    v_pk_add_f32 v[128:129], v[128:129], v[132:133]
    v_pk_add_f32 v[136:137], v[136:137], v[140:141]
    v_add_f32 v128, v128, v129
    v_add_f32 v136, v136, v137
    buffer_store_dword v128, v16, s[56:59], s30 offen sc1
    buffer_store_dword v136, v17, s[56:59], s30 offen sc1
    s_cmp_lg_u32 s28, s3
    s_cbranch_scc1 Lnr_229
    s_waitcnt vmcnt(2)
Ll_231:
    v_add_u32 v42, -1, v123
    v_max3_u32 v41, v228, v124, v125
    v_max3_u32 v41, v41, v126, v127
    v_max3_u32 v42, v42, v229, v230
    v_max3_u32 v41, v41, v42, v231
    v_max3_f32 v122, v228, v229, v230
    v_max_f32 v122, v122, v231
    v_cmp_eq_u32 vcc, -1, v41
    s_cbranch_vccz Lok_232
    buffer_load_dword v123, v182, s[52:55], 0 offen offset:128 sc1
    buffer_load_dwordx4 v[228:231], v12, s[56:59], s31 offen sc1
    buffer_load_dwordx4 v[124:127], v12, s[56:59], s31 offen offset:1024 sc1
    s_waitcnt vmcnt(0)
    s_sub_u32 s29, s29, 1
    s_cbranch_scc0 Ll_231
    s_mov_b32 s29, 0
Lok_232:
    v_max_f32_dpp v41, v122, v122 row_ror:8 row_mask:0xf bank_mask:0xf
    v_add_f32 v124, v124, v125
    v_add_f32 v126, v126, v127
    v_max_f32_dpp v41, v41, v41 row_ror:4 row_mask:0xf bank_mask:0xf
    v_add_f32 v124, v124, v126
    s_nop 0
    v_max_f32_dpp v41, v41, v41 row_ror:2 row_mask:0xf bank_mask:0xf
    s_nop 1
    v_max_f32_dpp v41, v41, v41 row_ror:1 row_mask:0xf bank_mask:0xf
    v_mov_b32 v45, v41
    s_nop 1
    v_permlane16_swap_b32 v41, v45
    v_max_f32 v41, v41, v45
    v_sub_f32 v40, v122, v41
    v_exp_f32 v40, v40
    s_nop 0
    v_mul_f32 v44, v124, v40
    s_nop 1
    v_add_f32_dpp v44, v44, v44 row_ror:8 row_mask:0xf bank_mask:0xf
    s_nop 1
    v_add_f32_dpp v44, v44, v44 row_ror:4 row_mask:0xf bank_mask:0xf
    s_nop 1
    v_add_f32_dpp v44, v44, v44 row_ror:2 row_mask:0xf bank_mask:0xf
    s_nop 1
    v_add_f32_dpp v44, v44, v44 row_ror:1 row_mask:0xf bank_mask:0xf
    v_mov_b32 v45, v44
    s_nop 1
    v_permlane16_swap_b32 v44, v45
    v_add_f32 v44, v44, v45
    v_rcp_f32 v120, v44
    v_rcp_f32 v121, v44
    s_nop 1
    v_permlane32_swap_b32 v120, v121
Lr_233:
    buffer_load_dwordx4 v[196:199], v13, s[56:59], s30 offen offset:0 sc1
    buffer_load_dwordx4 v[200:203], v13, s[56:59], s30 offen offset:1024 sc1
    buffer_load_dwordx4 v[204:207], v13, s[56:59], s30 offen offset:2048 sc1
    buffer_load_dwordx4 v[208:211], v13, s[56:59], s30 offen offset:3072 sc1
    s_waitcnt vmcnt(2)
    v_pk_add_f32 v[96:97], v[196:197], v[200:201]
    v_pk_add_f32 v[98:99], v[198:199], v[202:203]
    v_max3_u32 v44, v96, v97, v98
    v_mul_f32 v100, v96, v120
    v_mul_f32 v101, v97, v120
    v_mul_f32 v102, v98, v120
    v_mul_f32 v103, v99, v120
    s_waitcnt vmcnt(0)
    v_pk_add_f32 v[104:105], v[204:205], v[208:209]
    v_pk_add_f32 v[106:107], v[206:207], v[210:211]
    v_max3_u32 v44, v44, v99, v104
    v_max3_u32 v45, v105, v106, v107
    v_max_u32 v44, v44, v45
    v_cmp_eq_u32 vcc, -1, v44
    v_fmac_f32 v100, v104, v121
    v_fmac_f32 v101, v105, v121
    v_fmac_f32 v102, v106, v121
    v_fmac_f32 v103, v107, v121
    s_nop 0
    v_permlane32_swap_b32 v100, v102
    v_permlane32_swap_b32 v101, v103
    v_pk_add_f32 v[100:101], v[100:101], v[102:103]
    v_pk_add_f32 v[112:113], v[100:101], v[176:177]
    v_pk_add_f32 v[114:115], v[100:101], v[176:177]
    s_cbranch_vccnz Lre_235
Lok_234:
    s_nop 0
    v_permlane16_swap_b32 v112, v114
    v_permlane16_swap_b32 v113, v115
    v_pk_add_f32 v[112:113], v[112:113], v[114:115]
    v_cvt_pk_bf16_f32 v44, v112, v113
    buffer_store_dword v37, v30, s[56:59], s48 offen offset:0 sc1
    buffer_store_dword v44, v19, s[60:63], s49 offen sc1

    s_add_u32 s35, s49, s40
    s_add_u32 s49, s49, 16384
    v_and_b32 v181, 31, v2
    s_lshl_b32 s31, s34, 12
    v_lshl_add_u32 v181, v181, 7, s31
    s_add_u32 s30, s48, 102400
    buffer_load_dword v180, v181, s[56:59], s30 offen sc1
    s_cmp_lg_u32 s46, 0
    s_cbranch_scc1 Lv_236
    v_add_u32_dpp v186, v123, v123 quad_perm:[1,0,3,2] row_mask:0xf bank_mask:0xf
    s_nop 1
    v_add_u32_dpp v186, v186, v186 quad_perm:[2,3,0,1] row_mask:0xf bank_mask:0xf
    s_nop 1
    v_add_u32_dpp v186, v186, v186 row_half_mirror row_mask:0xf bank_mask:0xf
    s_bfe_u32 s31, s43, 0x10002
    v_readfirstlane_b32 s30, v186
    s_cmpk_gt_u32 s30, 512
    s_cselect_b32 s30, 1, 0
    s_xor_b32 s30, s30, s31
    s_lshl_b32 s40, s30, 13
    s_mov_b32 s35, s40
Lv_236:
    v_cndmask_b32 v178, 0, v112, s[92:93]
    v_cndmask_b32 v179, 0, v113, s[92:93]
    s_waitcnt vmcnt(0)
Lrs_237:
    buffer_load_dword v116, v22, s[60:63], s35 offen sc1
    buffer_load_dword v117, v23, s[60:63], s35 offen offset:256 sc1
    buffer_load_dword v118, v23, s[60:63], s35 offen offset:512 sc1
    buffer_load_dword v119, v23, s[60:63], s35 offen offset:768 sc1
    s_waitcnt vmcnt(0)
    v_max3_u32 v44, v116, v117, v118
    v_max_u32 v44, v44, v119
    v_cmp_eq_u32 vcc, -1, v44
    v_lshlrev_b32 v100, 16, v116
    v_and_b32 v101, 0xffff0000, v116
    v_lshlrev_b32 v102, 16, v117
    v_and_b32 v103, 0xffff0000, v117
    v_lshlrev_b32 v104, 16, v118
    v_and_b32 v105, 0xffff0000, v118
    v_lshlrev_b32 v106, 16, v119
    v_and_b32 v107, 0xffff0000, v119
    s_cbranch_vccnz Lre_239
Lok_238:
    v_pk_add_f32 v[100:101], v[100:101], v[102:103]
    v_pk_add_f32 v[104:105], v[104:105], v[106:107]
    v_pk_add_f32 v[100:101], v[100:101], v[178:179]
    v_pk_add_f32 v[176:177], v[100:101], v[104:105]
    s_add_u32 s30, s48, 102400
Lr_240:
    buffer_load_dwordx4 v[196:199], v13, s[56:59], s30 offen offset:0 sc1
    buffer_load_dwordx4 v[200:203], v13, s[56:59], s30 offen offset:1024 sc1
    buffer_load_dwordx4 v[204:207], v13, s[56:59], s30 offen offset:2048 sc1
    buffer_load_dwordx4 v[208:211], v14, s[56:59], s30 offen offset:3072 sc1
    s_waitcnt vmcnt(2)
    v_pk_add_f32 v[96:97], v[196:197], v[200:201]
    v_pk_add_f32 v[98:99], v[198:199], v[202:203]
    s_waitcnt vmcnt(0)
    v_pk_add_f32 v[104:105], v[204:205], v[208:209]
    v_pk_add_f32 v[106:107], v[206:207], v[210:211]
    v_pk_add_f32 v[100:101], v[104:105], v[96:97]
    v_pk_add_f32 v[102:103], v[106:107], v[98:99]
    v_max3_u32 v44, v100, v101, v102
    v_max_u32 v44, v44, v103
    v_cmp_eq_u32 vcc, -1, v44
    v_permlane32_swap_b32 v100, v102
    v_permlane32_swap_b32 v101, v103
    v_pk_add_f32 v[100:101], v[100:101], v[102:103]
    v_pk_add_f32 v[112:113], v[100:101], v[176:177]
    v_pk_add_f32 v[114:115], v[100:101], v[176:177]
    s_cbranch_vccnz Lre_242
Lok_241:
    s_nop 0
    v_permlane16_swap_b32 v112, v114
    v_permlane16_swap_b32 v113, v115
    v_pk_add_f32 v[112:113], v[112:113], v[114:115]
    v_cvt_pk_bf16_f32 v44, v112, v113
    buffer_store_dword v37, v30, s[56:59], s48 offen offset:1024 sc1
    buffer_store_dword v44, v19, s[60:63], s49 offen sc1

    s_add_u32 s35, s49, s40
    s_add_u32 s49, s49, 16384
    v_cndmask_b32 v178, 0, v112, s[92:93]
    v_cndmask_b32 v179, 0, v113, s[92:93]
    s_waitcnt vmcnt(0)
Lrs_243:
    buffer_load_dword v116, v22, s[60:63], s35 offen sc1
    buffer_load_dword v117, v23, s[60:63], s35 offen offset:256 sc1
    buffer_load_dword v118, v23, s[60:63], s35 offen offset:512 sc1
    buffer_load_dword v119, v23, s[60:63], s35 offen offset:768 sc1
    s_waitcnt vmcnt(0)
    v_max3_u32 v44, v116, v117, v118
    v_max_u32 v44, v44, v119
    v_cmp_eq_u32 vcc, -1, v44
    v_lshlrev_b32 v100, 16, v116
    v_and_b32 v101, 0xffff0000, v116
    v_lshlrev_b32 v102, 16, v117
    v_and_b32 v103, 0xffff0000, v117
    v_lshlrev_b32 v104, 16, v118
    v_and_b32 v105, 0xffff0000, v118
    v_lshlrev_b32 v106, 16, v119
    v_and_b32 v107, 0xffff0000, v119
    s_cbranch_vccnz Lre_245
Lok_244:
    v_pk_add_f32 v[100:101], v[100:101], v[102:103]
    v_pk_add_f32 v[104:105], v[104:105], v[106:107]
    v_pk_add_f32 v[100:101], v[100:101], v[178:179]
    v_pk_add_f32 v[176:177], v[100:101], v[104:105]
    s_cmp_lg_u32 s46, 0
    s_cbranch_scc1 Lfin_230
Lnr_229:
    s_cmp_lg_u32 s46, 0
    s_cbranch_scc1 L_end
    s_cmp_lt_u32 s34, 8
    s_cbranch_scc1 Lt_246
    s_mov_b32 s30, 131072
    buffer_load_dword v180, v15, s[56:59], s30 offen sc1
    s_mov_b32 s30, 98304
    buffer_load_dword v180, v15, s[56:59], s30 offen sc1
Lt_246:
    s_cmp_lg_u32 s28, 0
    s_cbranch_scc1 Lgo_247
Lgp_249:
    buffer_load_dword v40, v31, s[56:59], s48 offen offset:1024 sc1
    s_waitcnt vmcnt(0)
    v_cmp_eq_u32 vcc, -1, v40
    s_cbranch_vccnz Lre_251
Lok_250:
    ds_write_b32 v29, v37 offset:4
    s_branch Lgj_248
Lgo_247:
Lw_252:
    ds_read_b32 v40, v29 offset:4
    s_waitcnt lgkmcnt(0)
    v_cmp_eq_u32 vcc, -1, v40
    s_cbranch_vccnz Lre_254
Lok_253:
Lgj_248:
    v_and_b32 v46, 31, v9
Lf2_255:
    buffer_load_dword v173, v46, s[52:55], 0 offen offset:128 sc1
    s_waitcnt vmcnt(0)
    v_cmp_eq_u32 vcc, 0, v173
    s_cbranch_vccnz Lre_257
Lok_256:
    s_mov_b32 s44, s49
    v_add_u32_dpp v186, v173, v173 quad_perm:[1,0,3,2] row_mask:0xf bank_mask:0xf
    s_nop 1
    v_add_u32_dpp v186, v186, v186 quad_perm:[2,3,0,1] row_mask:0xf bank_mask:0xf
    s_nop 1
    v_add_u32_dpp v186, v186, v186 row_half_mirror row_mask:0xf bank_mask:0xf
    s_bfe_u32 s31, s43, 0x10002
    v_readfirstlane_b32 s30, v186
    s_cmpk_gt_u32 s30, 512
    s_cselect_b32 s30, 1, 0
    s_xor_b32 s30, s30, s31
    s_lshl_b32 s49, s30, 13
    s_add_u32 s49, s49, 16384
Lx_258:
    buffer_load_dwordx4 v[48:51], v20, s[60:63], s49 offen sc1
    buffer_load_dwordx4 v[52:55], v21, s[60:63], s49 offen sc1
    s_waitcnt vmcnt(1)
    v_mfma_f32_16x16x32_bf16 v[148:151], v[48:51], v[48:51], 0
    v_max3_u32 v40, v48, v49, v50
    v_mfma_f32_16x16x32_bf16 v[152:155], v[48:51], v[144:147], 0
    s_waitcnt vmcnt(0)
    v_mfma_f32_16x16x32_bf16 v[148:151], v[52:55], v[52:55], v[148:151]
    v_max3_u32 v40, v40, v51, v52
    v_max3_u32 v40, v40, v53, v54
    v_mfma_f32_16x16x32_bf16 v[152:155], v[52:55], v[144:147], v[152:155]
    v_max_u32 v40, v40, v55
    v_cmp_eq_u32 vcc, -1, v40
    s_nop 3
    v_pk_add_f32 v[40:41], v[148:149], v[150:151]
    v_add_f32 v40, v40, v41
    v_pk_add_f32 v[42:43], v[152:153], v[154:155]
    s_cbranch_vccnz Lre_260
Lok_259:
    s_mov_b32 s30, 229376
    buffer_load_dwordx4 v[44:47], v6, s[56:59], s30 offen sc1
    v_add_f32_dpp v40, v40, v40 quad_perm:[1,0,3,2] row_mask:0xf bank_mask:0xf
    v_add_f32 v42, v42, v43
    s_nop 0
    v_add_f32_dpp v40, v40, v40 quad_perm:[2,3,0,1] row_mask:0xf bank_mask:0xf
    s_nop 1
    v_add_f32_dpp v40, v40, v40 row_half_mirror row_mask:0xf bank_mask:0xf
    s_nop 1
    v_mov_b32_dpp v40, v40 row_ror:8 row_mask:0xc bank_mask:0xf
    v_cndmask_b32 v41, v42, v40, s[88:89]
    v_cndmask_b32 v40, v42, v40, s[88:89]
    s_nop 1
    v_permlane32_swap_b32 v40, v41
    v_add_f32 v42, v40, v41
    v_add_f32 v40, v40, v41
    s_nop 1
    v_permlane16_swap_b32 v40, v42
    v_add_f32 v40, v40, v42
    ds_write_b32 v240, v40 offset:32
Lqp_261:
    s_waitcnt vmcnt(0)
    ds_write_b128 v26, v[44:47]
    v_max3_u32 v40, v44, v45, v46
    v_max_u32 v40, v40, v47
    v_cmp_eq_u32 vcc, -1, v40
    s_cbranch_vccnz Lre_263
Lok_262:
    s_waitcnt lgkmcnt(0)
    s_barrier
    s_mov_b32 s49, s44
    s_mov_b32 s46, 1
    s_mov_b32 s48, 131072
    s_cmp_eq_u32 s26, 0
    s_cselect_b32 s45, 1, 0
    v_add_u32 v32, 32, v32
    v_add_u32 v10, 256, v10
    v_add_u32 v11, 256, v11
    s_branch L_oloop_s
    .p2align 6
Lfin_230:
    s_cmp_lg_u32 s26, 0
    s_cbranch_scc1 Lend_264
    v_pk_add_f32 v[112:113], v[100:101], v[104:105]
    v_pk_add_f32 v[114:115], v[100:101], v[104:105]
    s_nop 1
    v_permlane16_swap_b32 v112, v114
    v_permlane16_swap_b32 v113, v115
    v_pk_add_f32 v[112:113], v[112:113], v[114:115]
    v_cvt_pk_bf16_f32 v44, v112, v113
    buffer_store_dword v44, v27, s[64:67], 0 offen
Lend_264:
    s_endpgm
Lre_214:
    s_sub_u32 s29, s29, 1
    s_cbranch_scc0 Lw_212
    s_mov_b32 s29, 0
    s_branch Lok_213
Lre_217:
    s_sub_u32 s29, s29, 1
    s_cbranch_scc0 Lw_215
    s_mov_b32 s29, 0
    s_branch Lok_216
Lre_220:
    s_sub_u32 s29, s29, 1
    s_cbranch_scc0 Lm_218
    s_mov_b32 s29, 0
    s_branch Lok_219
Lre_224:
    buffer_load_dwordx4 v[188:191], v15, s[56:59], s48 offen sc1
    s_sub_u32 s29, s29, 1
    s_cbranch_scc0 Lo_221
    s_mov_b32 s29, 0
    s_waitcnt vmcnt(0)
    s_branch Lok_223
Lre_228:
    ds_read_b64 v[44:45], v11
    s_sub_u32 s29, s29, 1
    s_cbranch_scc0 Lox_225
    s_mov_b32 s29, 0
    s_waitcnt lgkmcnt(0)
    s_branch Lok_227
Lre_235:
    s_sub_u32 s29, s29, 1
    s_cbranch_scc0 Lr_233
    s_mov_b32 s29, 0
    s_cmp_eq_u32 s45, 1
    s_branch Lok_234
Lre_239:
    s_sub_u32 s29, s29, 1
    s_cbranch_scc0 Lrs_237
    s_mov_b32 s29, 0
    s_branch Lok_238
Lre_242:
    s_sub_u32 s29, s29, 1
    s_cbranch_scc0 Lr_240
    s_mov_b32 s29, 0
    s_cmp_eq_u32 s45, 1
    s_branch Lok_241
Lre_245:
    s_sub_u32 s29, s29, 1
    s_cbranch_scc0 Lrs_243
    s_mov_b32 s29, 0
    s_branch Lok_244
Lre_251:
    s_sub_u32 s29, s29, 1
    s_cbranch_scc0 Lgp_249
    s_mov_b32 s29, 0
    s_branch Lok_250
Lre_254:
    s_sub_u32 s29, s29, 1
    s_cbranch_scc0 Lw_252
    s_mov_b32 s29, 0
    s_branch Lok_253
Lre_257:
    s_sub_u32 s29, s29, 1
    s_cbranch_scc0 Lf2_255
    s_mov_b32 s29, 0
    s_branch Lok_256
Lre_260:
    s_sub_u32 s29, s29, 1
    s_cbranch_scc0 Lx_258
    s_mov_b32 s29, 0
    s_branch Lok_259
Lre_263:
    buffer_load_dwordx4 v[44:47], v6, s[56:59], s30 offen sc1
    s_sub_u32 s29, s29, 1
    s_cbranch_scc0 Lqp_261
    s_mov_b32 s29, 0
    s_waitcnt vmcnt(0)
    s_branch Lok_262
L_att_slow:
    v_smfmac_f32_16x16x64_bf16 v[192:195], v[172:175], v[56:63], v252
    v_pk_add_f32 v[180:181], v[180:181], v[182:183]
    v_pk_add_f32 v[176:177], v[176:177], v[178:179]
    v_smfmac_f32_16x16x64_bf16 v[196:199], v[168:171], v[80:87], v252
    v_add_f32 v180, v180, v181
    v_add_f32 v176, v176, v177
    v_smfmac_f32_16x16x64_bf16 v[196:199], v[172:175], v[88:95], v252
    v_mul_f32 v180, s49, v180
    v_fma_f32 v176, v176, s49, v184
    v_fma_f32 v176, -v180, v180, v176
    v_max_f32 v176, v184, v176
    v_rsq_f32 v176, v176
    s_cmp_eq_u32 s46, 0
    v_pk_add_f32 v[192:193], v[192:193], v[194:195]
    v_add_f32 v192, v192, v193
    v_pk_add_f32 v[196:197], v[196:197], v[198:199]
    v_add_f32 v196, v196, v197
    v_mul_f32 v176, s47, v176
    s_nop 0
    v_permlane32_swap_b32 v192, v196
    v_add_f32 v244, v192, v196
    s_nop 1
    v_max_f32_dpp v245, v244, v244 row_ror:8 row_mask:0xf bank_mask:0xf
    v_mul_f32 v244, v176, v244
    s_nop 0
    v_max_f32_dpp v245, v245, v245 row_ror:4 row_mask:0xf bank_mask:0xf
    s_nop 1
    v_max_f32_dpp v245, v245, v245 row_ror:2 row_mask:0xf bank_mask:0xf
    s_nop 1
    v_max_f32_dpp v245, v245, v245 row_ror:1 row_mask:0xf bank_mask:0xf
    v_mov_b32 v246, v245
    s_nop 1
    v_permlane32_swap_b32 v245, v246
    v_max_f32 v245, v245, v246
    v_fma_f32 v244, -v245, v176, v244
    v_exp_f32 v244, v244
    v_mul_f32 v245, v176, v245
    v_cvt_pk_bf16_f32 v246, v244, v244
    ds_write_b16 v17, v246
    ds_write_b32 v19, v245
    s_cbranch_scc1 Lh_265
    buffer_store_dword v245, v24, s[56:59], s48 offen sc1
Lhb_266:
Lp_270:
    ds_read_b128 v[200:203], v18
    s_mov_b64 exec, s[94:95]
    ds_read_b128 v[208:211], v20
    ds_read_b128 v[212:215], v20 offset:32
    s_mov_b64 exec, s[96:97]
    v_add_f32_dpp v246, v244, v244 row_ror:8 row_mask:0xf bank_mask:0xf
    s_waitcnt lgkmcnt(2)
    v_max3_u32 v205, v200, v201, v202
    v_max_u32 v205, v205, v203
    v_cmp_eq_u32 vcc, -1, v205
    v_max3_f32 v204, v200, v201, v202
    v_max_f32 v204, v204, v203
    s_cmp_eq_u32 s46, 0
    v_sub_f32 v200, v200, v204
    v_sub_f32 v201, v201, v204
    v_sub_f32 v202, v202, v204
    v_sub_f32 v203, v203, v204
    s_waitcnt lgkmcnt(0)
    s_cbranch_vccnz Lre_272
Lok_271:
    v_smfmac_f32_16x16x64_bf16 v[224:227], v[208:211], v[96:103], v253
    v_exp_f32 v200, v200
    v_smfmac_f32_16x16x64_bf16 v[228:231], v[208:211], v[112:119], v253
    v_exp_f32 v201, v201
    v_smfmac_f32_16x16x64_bf16 v[232:235], v[208:211], v[128:135], v253
    v_exp_f32 v202, v202
    v_smfmac_f32_16x16x64_bf16 v[236:239], v[208:211], v[144:151], v253
    v_exp_f32 v203, v203
    s_cbranch_scc1 Lv_273
Lvb_274:
    s_waitcnt lgkmcnt(12)
    v_smfmac_f32_16x16x64_bf16 v[224:227], v[212:215], v[104:111], v253
    s_waitcnt lgkmcnt(8)
    v_smfmac_f32_16x16x64_bf16 v[228:231], v[212:215], v[120:127], v253
    v_add_f32_dpp v246, v246, v246 row_ror:4 row_mask:0xf bank_mask:0xf
    s_waitcnt lgkmcnt(4)
    v_smfmac_f32_16x16x64_bf16 v[232:235], v[212:215], v[136:143], v253
    v_sub_f32 v245, v245, v204
    s_waitcnt lgkmcnt(0)
    v_smfmac_f32_16x16x64_bf16 v[236:239], v[212:215], v[152:159], v253
    v_pk_mul_f32 v[224:225], v[224:225], v[200:201]
    v_pk_fma_f32 v[224:225], v[226:227], v[202:203], v[224:225]
    v_add_f32 v240, v224, v225
    v_pk_mul_f32 v[228:229], v[228:229], v[200:201]
    v_pk_fma_f32 v[228:229], v[230:231], v[202:203], v[228:229]
    v_add_f32 v241, v228, v229
    v_pk_mul_f32 v[232:233], v[232:233], v[200:201]
    v_pk_fma_f32 v[232:233], v[234:235], v[202:203], v[232:233]
    v_add_f32 v242, v232, v233
    v_pk_mul_f32 v[236:237], v[236:237], v[200:201]
    v_pk_fma_f32 v[236:237], v[238:239], v[202:203], v[236:237]
    v_add_f32 v243, v236, v237
    buffer_store_dwordx4 v[240:243], v23, s[56:59], s48 offen sc1
    v_add_f32_dpp v246, v246, v246 row_ror:2 row_mask:0xf bank_mask:0xf
    v_exp_f32 v245, v245
    s_nop 0
    v_add_f32_dpp v246, v246, v246 row_ror:1 row_mask:0xf bank_mask:0xf
    v_mov_b32 v247, v246
    s_nop 1
    v_permlane32_swap_b32 v246, v247
    v_add_f32 v246, v246, v247
    v_mul_f32 v205, v246, v245
    buffer_store_dword v205, v24, s[56:59], s48 offen offset:1024 sc1
    s_branch L_att_join
Lre_269:
    s_sub_u32 s29, s29, 1
    s_cbranch_scc0 Lw_267
    s_mov_b32 s29, 0
    s_branch Lok_268
Lh_265:
    s_waitcnt vmcnt(8)
    ds_write_b32 v13, v12 offset:176
Lw_267:
    ds_read_b128 v[200:203], v26 offset:176
    s_waitcnt lgkmcnt(0)
    v_max3_u32 v200, v200, v201, v202
    v_max_u32 v200, v200, v203
    v_cmp_eq_u32 vcc, -1, v200
    s_cbranch_vccnz Lre_269
Lok_268:
    ds_read_b64_tr_b16 v[96:97], v21 offset:0
    ds_read_b64_tr_b16 v[98:99], v21 offset:2176
    ds_read_b64_tr_b16 v[112:113], v22 offset:32
    ds_read_b64_tr_b16 v[114:115], v22 offset:2208
    ds_read_b64_tr_b16 v[128:129], v21 offset:64
    ds_read_b64_tr_b16 v[130:131], v21 offset:2240
    ds_read_b64_tr_b16 v[144:145], v22 offset:96
    ds_read_b64_tr_b16 v[146:147], v22 offset:2272
    ds_read_b64_tr_b16 v[100:101], v21 offset:4352
    ds_read_b64_tr_b16 v[102:103], v21 offset:6528
    ds_read_b64_tr_b16 v[116:117], v22 offset:4384
    ds_read_b64_tr_b16 v[118:119], v22 offset:6560
    ds_read_b64_tr_b16 v[132:133], v21 offset:4416
    ds_read_b64_tr_b16 v[134:135], v21 offset:6592
    s_waitcnt lgkmcnt(12)
    ds_read_b64_tr_b16 v[148:149], v22 offset:4448
    ds_read_b64_tr_b16 v[150:151], v22 offset:6624
    s_waitcnt lgkmcnt(8)
    s_cmp_eq_u32 s46, 0
    s_branch Lhb_266
Lre_272:
    s_waitcnt lgkmcnt(0)
    s_sub_u32 s29, s29, 1
    s_cbranch_scc0 Lp_270
    s_mov_b32 s29, 0
    s_cmp_eq_u32 s46, 0
    s_branch Lok_271
Lre_277:
    s_sub_u32 s29, s29, 1
    s_cbranch_scc0 Lw_275
    s_mov_b32 s29, 0
    s_branch Lok_276
Lv_273:
    s_waitcnt vmcnt(0)
    ds_write_b32 v13, v12 offset:64
    buffer_store_dword v245, v24, s[56:59], s48 offen sc1
Lw_275:
    ds_read_b128 v[248:251], v26 offset:64
    s_waitcnt lgkmcnt(0)
    v_max3_u32 v248, v248, v249, v250
    v_max_u32 v248, v248, v251
    v_cmp_eq_u32 vcc, -1, v248
    s_cbranch_vccnz Lre_277
Lok_276:
    ds_read_b64_tr_b16 v[104:105], v21 offset:8704
    ds_read_b64_tr_b16 v[106:107], v21 offset:10880
    ds_read_b64_tr_b16 v[108:109], v21 offset:13056
    ds_read_b64_tr_b16 v[110:111], v21 offset:15232
    ds_read_b64_tr_b16 v[120:121], v22 offset:8736
    ds_read_b64_tr_b16 v[122:123], v22 offset:10912
    ds_read_b64_tr_b16 v[124:125], v22 offset:13088
    ds_read_b64_tr_b16 v[126:127], v22 offset:15264
    ds_read_b64_tr_b16 v[136:137], v21 offset:8768
    ds_read_b64_tr_b16 v[138:139], v21 offset:10944
    ds_read_b64_tr_b16 v[140:141], v21 offset:13120
    ds_read_b64_tr_b16 v[142:143], v21 offset:15296
    ds_read_b64_tr_b16 v[152:153], v22 offset:8800
    ds_read_b64_tr_b16 v[154:155], v22 offset:10976
    s_waitcnt lgkmcnt(12)
    ds_read_b64_tr_b16 v[156:157], v22 offset:13152
    ds_read_b64_tr_b16 v[158:159], v22 offset:15328
    s_branch Lvb_274
L_end:
    s_endpgm

.section .rodata,"a"
.p2align 6
.amdhsa_kernel interleave_layers__sliding_block_cached__dense_activation_silu__decode_kernel
  .amdhsa_next_free_vgpr 256
  .amdhsa_next_free_sgpr 102
  .amdhsa_accum_offset 256
  .amdhsa_group_segment_fixed_size 0
  .amdhsa_kernarg_size 88
  .amdhsa_user_sgpr_count 2
  .amdhsa_user_sgpr_kernarg_segment_ptr 1
  .amdhsa_system_sgpr_workgroup_id_x 1
.end_amdhsa_kernel
```
